```python
import torch

def _softmax(x, axis=-1):
    return torch.softmax(x, dim=axis)
def _gelu(x):
    return torch.nn.functional.gelu(x, approximate="tanh")
def _silu(x):
    return torch.nn.functional.silu(x)
def _sigmoid(x):
    return torch.sigmoid(x)
def _layernorm(x, axis=-1, eps=1e-5):
    m = x.mean(dim=axis, keepdim=True)
    v = x.var(dim=axis, keepdim=True, unbiased=False)
    return (x - m) / torch.sqrt(v + eps)
def _scatter_add(tgt, idx, src, axis=0):
    return tgt.clone().index_add_(axis, idx, src)
def _segment_sum(src, seg, n):
    out = torch.zeros((n,) + src.shape[1:], dtype=src.dtype)
    return out.index_add_(0, seg, src)
def _pad(x, pw):
    flat = tuple(v for pair in reversed(pw) for v in pair)
    return torch.nn.functional.pad(x, flat)

kernel_name = 'gather_scatter__edge_featured_mpnn_gatedgcn__graph'

def setup_inputs():

    _w = (lambda a: (lambda t: t.to(torch.bfloat16) if t.is_floating_point() else t)(torch.as_tensor(a)))
    N, deg, D, De = 12500, 32, 128, max(16, 1)
    E = N * deg
    return {
        "x": _w((lambda *s: torch.randn(*s, dtype=torch.bfloat16) * 0.4)(N, D)),
        "e_attr": _w((lambda *s: torch.randn(*s, dtype=torch.bfloat16) * 0.8)(E, De)),
        "src": _w((lambda lo, hi, *s: torch.randint(lo, hi, s))(0, N, E).to(torch.int64)),
        "dst": _w((lambda lo, hi, *s: torch.randint(lo, hi, s))(0, N, E).to(torch.int64)),
        "w_a": _w((lambda *s: torch.randn(*s, dtype=torch.bfloat16) * 0.4)(D, D)),
        "w_b": _w((lambda *s: torch.randn(*s, dtype=torch.bfloat16) * 0.4)(D, D)),
        "w_c": _w((lambda *s: torch.randn(*s, dtype=torch.bfloat16) * 0.8)(De, D)),
        "w_u": _w((lambda *s: torch.randn(*s, dtype=torch.bfloat16) * 0.05)(D, D)),
        "w_v": _w((lambda *s: torch.randn(*s, dtype=torch.bfloat16) * 0.05)(D, D)),
    }

def reference(x, e_attr, src, dst, w_a, w_b, w_c, w_u, w_v):
    N, D = x.shape
    hv = x @ w_v
    g = x[dst] @ w_a + x[src] @ w_b + e_attr @ w_c
    eta = _sigmoid(g)
    denom = _segment_sum(eta, dst, N) + 1e-6
    eta_n = eta / denom[dst]
    agg = _segment_sum(eta_n * hv[src], dst, N)
    z = x @ w_u + agg
    relu_z = torch.where(z > 0, z, 0 * z)
    return x + relu_z
```

```asm
; @launch grid=(256,1,1) block=(512,1,1) lds=162304
.amdgcn_target "amdgcn-amd-amdhsa--gfx950"
.text
.globl gather_scatter__edge_featured_mpnn_gatedgcn__graph_kernel
.p2align 8
.type gather_scatter__edge_featured_mpnn_gatedgcn__graph_kernel,@function
gather_scatter__edge_featured_mpnn_gatedgcn__graph_kernel:
    s_cmp_ge_u32 s2, 256
    s_cbranch_scc1 Lk2_exit
    s_load_dwordx16 s[4:19], s[0:1], 0
    s_load_dwordx8 s[20:27], s[0:1], 64
    s_memrealtime s[74:75]
    s_getpc_b64 s[72:73]
    s_lshr_b32 s3, s2, 3
    s_and_b32 s3, s3, 15
    v_subrev_u32 v1, 504, v0
    v_cmp_gt_u32 vcc, 8, v1
    v_mul_u32_u24 v1, 16, v1
    v_add_lshl_u32 v1, v1, s3, 7
    s_and_saveexec_b64 s[68:69], vcc
    s_cbranch_execz Lno_cpf
    global_load_dword v2, v1, s[72:73]
Lno_cpf:
    s_mov_b64 exec, -1
    v_mov_b32 v153, 0
    v_lshlrev_b32 v159, 2, v0
    ds_write_b32 v159, v153 offset:4096
    ds_write_b32 v159, v153 offset:0
    v_lshrrev_b32 v148, 6, v0
    v_lshlrev_b32 v150, 4, v0
    v_readfirstlane_b32 s56, v148
    s_movk_i32 s3, 392
    s_cmp_eq_u32 s2, 255
    s_cselect_b32 s3, 40, s3
    v_cmp_gt_u32_e64 s[66:67], s3, v0
    s_mul_i32 s94, s2, 6272
    s_mov_b32 s78, 1600000
    s_mov_b32 s79, 0x20000
    s_mov_b32 s82, 1600000
    s_mov_b32 s83, 0x20000
    s_and_b32 s3, s2, 7
    s_lshl_b32 s3, s3, 5
    s_bfe_u32 s57, s2, 0x50003
    s_add_u32 s57, s57, s3
    s_mul_i32 s58, s57, 799999
    s_add_u32 s99, s58, 816329
    s_add_u32 s58, s58, 16330
    s_lshr_b32 s99, s99, 14
    s_lshr_b32 s58, s58, 14
    v_mov_b32 v243, v0
    v_and_b32 v151, 0x3f0, v150
    v_bfe_u32 v149, v0, 4, 2
    v_lshlrev_b32 v152, 6, v149
    v_xor_b32 v160, v151, v152
    v_xor_b32 v161, 32, v160
    s_lshl_b32 s97, s56, 13
    s_add_u32 s98, s97, 4096
    s_and_b32 s92, s97, 0x7fff
    s_add_u32 s93, s92, 4096
    s_lshl_b32 s72, s58, 8
    s_add_u32 s73, s72, 8192
    s_mov_b64 exec, s[66:67]
    s_waitcnt lgkmcnt(0)
    s_cbranch_execz Lp_nold
    s_mov_b64 s[76:77], s[10:11]
    s_mov_b64 s[80:81], s[8:9]
    buffer_load_dwordx4 v[108:111], v150, s[76:79], s94 offen nt
    buffer_load_dwordx4 v[112:115], v150, s[80:83], s94 offen nt
Lp_nold:
    s_cmp_lg_u32 s56, 7
    s_cbranch_scc1 Lno_wpf
    s_mov_b64 exec, 0xff
    s_lshr_b32 s3, s2, 3
    s_lshl_b32 s3, s3, 10
    v_lshl_add_u32 v1, v151, 3, s3
    global_load_dword v3, v1, s[14:15]
    global_load_dword v4, v1, s[20:21]
    global_load_dword v5, v1, s[12:13]
    global_load_dword v6, v1, s[18:19]
Lno_wpf:
    s_mov_b64 exec, -1
    s_barrier
    s_mov_b64 s[80:81], s[24:25]
    s_mov_b32 s82, 0x100
    s_mov_b32 s83, 0x20000
    s_xor_b32 s3, s56, 7
    s_or_b32 s3, s3, s2
    s_cbranch_scc1 Lno_nonce
    s_or_b32 s3, s74, 1
    v_mov_b32 v104, s3
    v_mov_b32 v105, s75
    s_mov_b64 exec, 1
    buffer_store_dwordx2 v[104:105], v153, s[80:83], 0 offen sc1
    s_mov_b64 exec, -1
Lno_nonce:
    s_mov_b64 s[48:49], s[4:5]
    s_lshl_b32 s50, s99, 8
    s_mov_b32 s51, 0x20000
    s_sub_u32 s0, s99, s58
    buffer_load_dwordx4 v[96:99], v150, s[48:51], s72 offen nt
    buffer_load_dwordx4 v[100:103], v150, s[48:51], s73 offen nt
    s_cmp_lt_u32 s56, 4
    s_cselect_b32 s84, s14, s20
    s_cselect_b32 s85, s15, s21
    s_cselect_b32 s88, s12, s18
    s_cselect_b32 s89, s13, s19
    s_mov_b32 s86, 32768
    s_mov_b32 s87, 0x20000
    s_mov_b32 s90, 32768
    s_mov_b32 s91, 0x20000
    s_cmp_lg_u32 s56, 7
    s_cbranch_scc1 Lno_ld0
    s_mov_b64 s[84:85], s[14:15]
    s_mov_b32 m0, 96768
    s_movk_i32 s3, 0
    buffer_load_dwordx4 v160, s[84:87], s3 offen offset:0  lds
    buffer_load_dwordx4 v160, s[84:87], s3 offen offset:1024  lds
    buffer_load_dwordx4 v161, s[84:87], s3 offen offset:2048  lds
    buffer_load_dwordx4 v161, s[84:87], s3 offen offset:3072  lds
    s_mov_b32 m0, 100864
    s_movk_i32 s3, 4096
    buffer_load_dwordx4 v160, s[84:87], s3 offen offset:0  lds
    buffer_load_dwordx4 v160, s[84:87], s3 offen offset:1024  lds
    buffer_load_dwordx4 v161, s[84:87], s3 offen offset:2048  lds
    buffer_load_dwordx4 v161, s[84:87], s3 offen offset:3072  lds
Lno_ld0:
    s_mov_b64 s[76:77], s[16:17]
    s_mov_b32 s78, 0x1000
    s_mov_b32 s79, 0x20000
    s_add_u32 s36, s26, 0xe00000
    s_addc_u32 s37, s27, 0
    s_mov_b32 s38, 0x188000
    s_mov_b32 s39, 0x20000
    s_add_u32 s40, s26, 0x1000000
    s_addc_u32 s41, s27, 0
    s_mov_b32 s42, 0x80800
    s_mov_b32 s43, 0x20000
    s_add_u32 s28, s26, 0x1000
    s_addc_u32 s29, s27, 0
    s_mov_b32 s30, 0x622800
    s_mov_b32 s31, 0x20000
    s_mov_b64 s[32:33], s[6:7]
    s_mov_b32 s34, 0xc35000
    s_mov_b32 s35, 0x20000
    s_mov_b64 s[52:53], s[22:23]
    s_mov_b32 s54, 0x30d400
    s_mov_b32 s55, 0x20000
    s_lshl_b32 s3, s58, 9
    s_add_u32 s44, s28, s3
    s_addc_u32 s45, s29, 0
    s_lshl_b32 s46, s0, 9
    s_mov_b32 s47, 0x20000
    s_mov_b32 s63, 0xbfb8aa3b
    s_mov_b32 s64, 0x27800000
    s_mov_b32 s65, 0x27800000
    s_mov_b32 s59, 0
    s_mov_b32 s95, 171799
    s_mov_b32 s96, -799999
    v_mov_b32 v154, 1
    v_lshrrev_b32 v159, 4, v243
    v_lshl_add_u32 v155, v159, 4, v150
    v_add_u32 v155, 82432, v155
    v_and_b32 v236, 0x1f0, v150
    v_bfe_u32 v152, v243, 5, 1
    v_mov_b32 v237, v236
    v_lshlrev_b32 v241, 4, v152
    s_lshr_b32 s72, s56, 2
    s_and_b32 s73, s56, 3
    v_bfe_u32 v159, v243, 2, 2
    v_xor_b32 v168, s73, v159
    v_lshlrev_b32 v168, 6, v168
    v_and_b32 v169, 3, v243
    v_lshl_add_u32 v168, v169, 3, v168
    v_lshl_add_u32 v168, v159, 8, v168
    v_and_b32 v169, 1, v149
    v_xor_b32 v169, v169, v152
    v_lshl_add_u32 v168, v169, 5, v168
    v_lshl_add_u32 v168, v152, 11, v168
    v_add_u32 v163, 96768, v168
    s_lshl_b32 s3, s72, 15
    s_add_u32 s3, s3, 12800
    v_add_u32 v166, s3, v168
    v_and_b32 v159, 31, v243
    v_mul_u32_u24 v156, 272, v159
    s_mov_b32 s3, 82432
    v_add3_u32 v156, v156, v241, s3
    s_mul_i32 s3, s72, 8704
    v_add_u32 v162, s3, v156
    s_mul_i32 s3, s56, 4608
    s_add_u32 s3, s3, 96768
    v_mul_u32_u24 v164, 144, v159
    v_add3_u32 v164, v164, v241, s3
    v_bfe_u32 v168, v243, 3, 3
    v_lshl_add_u32 v147, v168, 4, v151
    v_add_u32 v147, s3, v147
    v_and_b32 v169, 0x70, v151
    v_lshl_add_u32 v165, v168, 9, v169
    s_lshl_b32 s3, s72, 7
    s_add_u32 s3, s3, s73
    s_lshl_b32 s3, s3, 7
    v_add_u32 v165, s3, v165
    v_mul_u32_u24 v157, 528, v159
    s_mul_i32 s3, s72, 27456
    s_lshl_b32 s73, s73, 7
    s_add_u32 s3, s3, s73
    s_add_u32 s3, s3, 97296
    v_add3_u32 v157, v157, v241, s3
    v_lshrrev_b32 v167, 1, v243
    v_lshlrev_b32 v167, 11, v167
    v_lshlrev_b32 v168, 8, v243
    v_add_u32 v169, 64, v168
    v_add_u32 v170, 0x80, v168
    v_add_u32 v171, 0xc0, v168
    s_cmp_eq_u32 s56, 7
    s_cbranch_scc1 Lp_loader
    s_mov_b64 exec, s[66:67]
    s_waitcnt vmcnt(2)
    v_mul_u32_u24 v124, s95, v108
    v_mul_u32_u24 v125, s95, v109
    v_mul_u32_u24 v126, s95, v110
    v_mul_u32_u24 v127, s95, v111
    v_lshrrev_b32 v124, 23, v124
    v_lshlrev_b32 v116, 2, v124
    ds_add_rtn_u32 v120, v116, v154 offset:4352
    v_lshrrev_b32 v125, 23, v125
    v_lshlrev_b32 v117, 2, v125
    ds_add_rtn_u32 v121, v117, v154 offset:4352
    v_lshrrev_b32 v126, 23, v126
    v_lshlrev_b32 v118, 2, v126
    ds_add_rtn_u32 v122, v118, v154 offset:4352
    v_lshrrev_b32 v127, 23, v127
    v_lshlrev_b32 v119, 2, v127
    ds_add_rtn_u32 v123, v119, v154 offset:4352
    v_lshl_add_u32 v108, v108, 14, 53
    v_mad_i32_i24 v108, v124, s96, v108
    v_lshl_add_u32 v109, v109, 14, 53
    v_mad_i32_i24 v109, v125, s96, v109
    v_lshl_add_u32 v110, v110, 14, 53
    v_mad_i32_i24 v110, v126, s96, v110
    v_lshl_add_u32 v111, v111, 14, 53
    v_mad_i32_i24 v111, v127, s96, v111
    s_mov_b64 exec, -1
    s_cmp_eq_u32 s56, 3
    s_waitcnt lgkmcnt(0)
    s_barrier
    s_cbranch_scc0 Lp_noscan
    ds_read_b128 v[124:127], v151 offset:4352
    s_waitcnt lgkmcnt(0)
    v_add_u32 v130, v124, v125
    v_add3_u32 v133, v130, v126, v127
    v_add_u32 v131, v130, v126
    v_mov_b32 v132, v133
    v_add_u32_dpp v133, v133, v133 row_shr:1 row_mask:0xf bank_mask:0xf
    v_lshl_or_b32 v112, v112, 18, v168
    v_lshrrev_b32 v108, 14, v108
    v_add_u32_dpp v133, v133, v133 row_shr:2 row_mask:0xf bank_mask:0xf
    v_or_b32 v112, v112, v108
    v_lshl_or_b32 v113, v113, 18, v169
    v_add_u32_dpp v133, v133, v133 row_shr:4 row_mask:0xf bank_mask:0xf
    v_lshrrev_b32 v109, 14, v109
    v_or_b32 v113, v113, v109
    v_add_u32_dpp v133, v133, v133 row_shr:8 row_mask:0xf bank_mask:0xf
    v_lshl_or_b32 v114, v114, 18, v170
    v_lshrrev_b32 v110, 14, v110
    v_add_u32_dpp v133, v133, v133 row_bcast:15 row_mask:0xa bank_mask:0xf
    v_or_b32 v114, v114, v110
    v_lshl_or_b32 v115, v115, 18, v171
    v_add_u32_dpp v133, v133, v133 row_bcast:31 row_mask:0xc bank_mask:0xf
    v_sub_u32 v128, v133, v132
    v_add_u32 v129, v128, v124
    v_add_u32 v130, v128, v130
    v_add_u32 v131, v128, v131
    ds_write_b128 v151, v[128:131] offset:5376
    v_lshrrev_b32 v111, 14, v111
    v_or_b32 v115, v115, v111
    s_waitcnt lgkmcnt(0)
    s_barrier
    s_branch Lp_scanned
Lp_noscan:
    v_lshl_or_b32 v112, v112, 18, v168
    v_lshrrev_b32 v108, 14, v108
    v_or_b32 v112, v112, v108
    v_lshl_or_b32 v113, v113, 18, v169
    v_lshrrev_b32 v109, 14, v109
    v_or_b32 v113, v113, v109
    v_lshl_or_b32 v114, v114, 18, v170
    v_lshrrev_b32 v110, 14, v110
    v_or_b32 v114, v114, v110
    v_lshl_or_b32 v115, v115, 18, v171
    v_lshrrev_b32 v111, 14, v111
    v_or_b32 v115, v115, v111
    s_barrier
Lp_scanned:
    s_mov_b64 exec, s[66:67]
    ds_read_b32 v116, v116 offset:5376
    ds_read_b32 v117, v117 offset:5376
    ds_read_b32 v118, v118 offset:5376
    ds_read_b32 v119, v119 offset:5376
    s_waitcnt lgkmcnt(0)
    v_add_lshl_u32 v116, v116, v120, 2
    ds_write_b32 v116, v112 offset:6400
    v_add_lshl_u32 v117, v117, v121, 2
    ds_write_b32 v117, v113 offset:6400
    v_add_lshl_u32 v118, v118, v122, 2
    ds_write_b32 v118, v114 offset:6400
    v_add_lshl_u32 v119, v119, v123, 2
    ds_write_b32 v119, v115 offset:6400
    s_mov_b64 exec, -1
    buffer_load_dwordx2 v[104:105], v153, s[80:83], 0 offen sc1
    s_waitcnt lgkmcnt(0)
    s_barrier
    ds_read_b128 v[108:111], v150 offset:6400
    s_mov_b64 exec, s[66:67]
    s_cbranch_execz Lp_none
    s_waitcnt lgkmcnt(0)
    buffer_store_dwordx4 v[108:111], v150, s[36:39], s94 offen sc1
    s_branch Lp_out
Lp_loader:
    s_mov_b32 m0, 104960
    s_movk_i32 s3, 8192
    buffer_load_dwordx4 v160, s[84:87], s3 offen offset:0  lds
    buffer_load_dwordx4 v160, s[84:87], s3 offen offset:1024  lds
    buffer_load_dwordx4 v161, s[84:87], s3 offen offset:2048  lds
    buffer_load_dwordx4 v161, s[84:87], s3 offen offset:3072  lds
    s_mov_b32 m0, 109056
    s_movk_i32 s3, 12288
    buffer_load_dwordx4 v160, s[84:87], s3 offen offset:0  lds
    buffer_load_dwordx4 v160, s[84:87], s3 offen offset:1024  lds
    buffer_load_dwordx4 v161, s[84:87], s3 offen offset:2048  lds
    buffer_load_dwordx4 v161, s[84:87], s3 offen offset:3072  lds
    s_mov_b32 m0, 113152
    s_movk_i32 s3, 16384
    buffer_load_dwordx4 v160, s[84:87], s3 offen offset:0  lds
    buffer_load_dwordx4 v160, s[84:87], s3 offen offset:1024  lds
    buffer_load_dwordx4 v161, s[84:87], s3 offen offset:2048  lds
    buffer_load_dwordx4 v161, s[84:87], s3 offen offset:3072  lds
    s_mov_b32 m0, 117248
    s_movk_i32 s3, 20480
    buffer_load_dwordx4 v160, s[84:87], s3 offen offset:0  lds
    buffer_load_dwordx4 v160, s[84:87], s3 offen offset:1024  lds
    buffer_load_dwordx4 v161, s[84:87], s3 offen offset:2048  lds
    buffer_load_dwordx4 v161, s[84:87], s3 offen offset:3072  lds
    s_barrier
    s_mov_b32 m0, 121344
    s_movk_i32 s3, 24576
    buffer_load_dwordx4 v160, s[84:87], s3 offen offset:0  lds
    buffer_load_dwordx4 v160, s[84:87], s3 offen offset:1024  lds
    buffer_load_dwordx4 v161, s[84:87], s3 offen offset:2048  lds
    buffer_load_dwordx4 v161, s[84:87], s3 offen offset:3072  lds
    s_mov_b32 m0, 125440
    s_movk_i32 s3, 28672
    buffer_load_dwordx4 v160, s[84:87], s3 offen offset:0  lds
    buffer_load_dwordx4 v160, s[84:87], s3 offen offset:1024  lds
    buffer_load_dwordx4 v161, s[84:87], s3 offen offset:2048  lds
    buffer_load_dwordx4 v161, s[84:87], s3 offen offset:3072  lds
    s_mov_b32 m0, 129536
    s_movk_i32 s3, 0
    s_mov_b64 s[84:85], s[20:21]
    buffer_load_dwordx4 v160, s[84:87], s3 offen offset:0  lds
    buffer_load_dwordx4 v160, s[84:87], s3 offen offset:1024  lds
    buffer_load_dwordx4 v161, s[84:87], s3 offen offset:2048  lds
    buffer_load_dwordx4 v161, s[84:87], s3 offen offset:3072  lds
    s_mov_b32 m0, 133632
    s_movk_i32 s3, 4096
    buffer_load_dwordx4 v160, s[84:87], s3 offen offset:0  lds
    buffer_load_dwordx4 v160, s[84:87], s3 offen offset:1024  lds
    buffer_load_dwordx4 v161, s[84:87], s3 offen offset:2048  lds
    buffer_load_dwordx4 v161, s[84:87], s3 offen offset:3072  lds
    s_mov_b32 m0, 137728
    s_movk_i32 s3, 8192
    buffer_load_dwordx4 v160, s[84:87], s3 offen offset:0  lds
    buffer_load_dwordx4 v160, s[84:87], s3 offen offset:1024  lds
    buffer_load_dwordx4 v161, s[84:87], s3 offen offset:2048  lds
    buffer_load_dwordx4 v161, s[84:87], s3 offen offset:3072  lds
    s_barrier
    s_mov_b32 m0, 141824
    s_movk_i32 s3, 12288
    buffer_load_dwordx4 v160, s[84:87], s3 offen offset:0  lds
    buffer_load_dwordx4 v160, s[84:87], s3 offen offset:1024  lds
    buffer_load_dwordx4 v161, s[84:87], s3 offen offset:2048  lds
    buffer_load_dwordx4 v161, s[84:87], s3 offen offset:3072  lds
    s_mov_b32 m0, 145920
    s_movk_i32 s3, 16384
    buffer_load_dwordx4 v160, s[84:87], s3 offen offset:0  lds
    buffer_load_dwordx4 v160, s[84:87], s3 offen offset:1024  lds
    buffer_load_dwordx4 v161, s[84:87], s3 offen offset:2048  lds
    buffer_load_dwordx4 v161, s[84:87], s3 offen offset:3072  lds
    s_mov_b32 m0, 150016
    s_movk_i32 s3, 20480
    buffer_load_dwordx4 v160, s[84:87], s3 offen offset:0  lds
    buffer_load_dwordx4 v160, s[84:87], s3 offen offset:1024  lds
    buffer_load_dwordx4 v161, s[84:87], s3 offen offset:2048  lds
    buffer_load_dwordx4 v161, s[84:87], s3 offen offset:3072  lds
    s_mov_b32 m0, 154112
    s_movk_i32 s3, 24576
    buffer_load_dwordx4 v160, s[84:87], s3 offen offset:0  lds
    buffer_load_dwordx4 v160, s[84:87], s3 offen offset:1024  lds
    buffer_load_dwordx4 v161, s[84:87], s3 offen offset:2048  lds
    buffer_load_dwordx4 v161, s[84:87], s3 offen offset:3072  lds
    s_mov_b32 m0, 158208
    s_movk_i32 s3, 28672
    buffer_load_dwordx4 v160, s[84:87], s3 offen offset:0  lds
    buffer_load_dwordx4 v160, s[84:87], s3 offen offset:1024  lds
    buffer_load_dwordx4 v161, s[84:87], s3 offen offset:2048  lds
    buffer_load_dwordx4 v161, s[84:87], s3 offen offset:3072  lds
    s_barrier
    buffer_load_dwordx2 v[104:105], v153, s[80:83], 0 offen sc1
Lp_none:
    s_waitcnt vmcnt(1)
Lp_out:
    s_mov_b64 exec, -1
    s_waitcnt vmcnt(2)
    ds_write_b128 v155, v[96:99]
    s_cmp_lt_u32 s56, 5
    s_cselect_b64 exec, -1, 0
    ds_write_b128 v155, v[100:103] offset:8704
    s_mov_b64 exec, -1
    v_lshrrev_b32 v159, 1, v150
    v_and_b32 v159, 0x3ff, v159
    ds_read_b64 v[124:125], v159 offset:4352
    ds_read_b64 v[128:129], v159 offset:5376
    s_lshl_b32 s3, s56, 9
    s_add_u32 m0, s3, 78336
    s_waitcnt lgkmcnt(0)
    s_barrier
    ds_read_b128 v[8:11], v162 offset:0
    ds_read_b64_tr_b16 v[0:1], v163 offset:0
    ds_read_b64_tr_b16 v[2:3], v163 offset:1024
    ds_read_b64_tr_b16 v[4:5], v163 offset:32768
    ds_read_b64_tr_b16 v[6:7], v163 offset:33792
    ds_read_b128 v[20:23], v162 offset:32
    ds_read_b64_tr_b16 v[12:13], v163 offset:4096
    ds_read_b64_tr_b16 v[14:15], v163 offset:5120
    ds_read_b64_tr_b16 v[16:17], v163 offset:36864
    ds_read_b64_tr_b16 v[18:19], v163 offset:37888
    ds_read_b128 v[32:35], v162 offset:64
    ds_read_b64_tr_b16 v[24:25], v163 offset:8192
    ds_read_b64_tr_b16 v[26:27], v163 offset:9216
    ds_read_b64_tr_b16 v[28:29], v163 offset:40960
    ds_read_b64_tr_b16 v[30:31], v163 offset:41984
    s_mov_b32 exec_hi, 0
    buffer_load_dwordx4 v151, s[76:79], s3 offen lds
    s_mov_b32 exec_hi, -1
    s_waitcnt lgkmcnt(10)
    v_mfma_f32_32x32x16_bf16 v[48:63], v[0:3], v[8:11], 0
    v_mfma_f32_32x32x16_bf16 v[64:79], v[4:7], v[8:11], 0
    ds_read_b128 v[44:47], v162 offset:96
    ds_read_b64_tr_b16 v[36:37], v163 offset:12288
    ds_read_b64_tr_b16 v[38:39], v163 offset:13312
    ds_read_b64_tr_b16 v[40:41], v163 offset:45056
    ds_read_b64_tr_b16 v[42:43], v163 offset:46080
    s_add_u32 m0, s97, 12800
    s_nop 0
    buffer_load_dwordx4 v160, s[88:91], s92 offen offset:0  lds
    buffer_load_dwordx4 v160, s[88:91], s92 offen offset:1024  lds
    s_waitcnt lgkmcnt(10)
    v_mfma_f32_32x32x16_bf16 v[48:63], v[12:15], v[20:23], v[48:63]
    v_mfma_f32_32x32x16_bf16 v[64:79], v[16:19], v[20:23], v[64:79]
    ds_read_b128 v[8:11], v162 offset:128
    ds_read_b64_tr_b16 v[0:1], v163 offset:16384
    ds_read_b64_tr_b16 v[2:3], v163 offset:17408
    ds_read_b64_tr_b16 v[4:5], v163 offset:49152
    ds_read_b64_tr_b16 v[6:7], v163 offset:50176
    buffer_load_dwordx4 v161, s[88:91], s92 offen offset:2048  lds
    buffer_load_dwordx4 v161, s[88:91], s92 offen offset:3072  lds
    s_waitcnt lgkmcnt(10)
    v_mfma_f32_32x32x16_bf16 v[48:63], v[24:27], v[32:35], v[48:63]
    v_mfma_f32_32x32x16_bf16 v[64:79], v[28:31], v[32:35], v[64:79]
    ds_read_b128 v[20:23], v162 offset:160
    ds_read_b64_tr_b16 v[12:13], v163 offset:20480
    ds_read_b64_tr_b16 v[14:15], v163 offset:21504
    ds_read_b64_tr_b16 v[16:17], v163 offset:53248
    ds_read_b64_tr_b16 v[18:19], v163 offset:54272
    s_add_u32 m0, s98, 12800
    s_nop 0
    buffer_load_dwordx4 v160, s[88:91], s93 offen offset:0  lds
    buffer_load_dwordx4 v160, s[88:91], s93 offen offset:1024  lds
    s_waitcnt lgkmcnt(10)
    v_mfma_f32_32x32x16_bf16 v[48:63], v[36:39], v[44:47], v[48:63]
    v_mfma_f32_32x32x16_bf16 v[64:79], v[40:43], v[44:47], v[64:79]
    ds_read_b128 v[32:35], v162 offset:192
    ds_read_b64_tr_b16 v[24:25], v163 offset:24576
    ds_read_b64_tr_b16 v[26:27], v163 offset:25600
    ds_read_b64_tr_b16 v[28:29], v163 offset:57344
    ds_read_b64_tr_b16 v[30:31], v163 offset:58368
    buffer_load_dwordx4 v161, s[88:91], s93 offen offset:2048  lds
    buffer_load_dwordx4 v161, s[88:91], s93 offen offset:3072  lds
    s_waitcnt lgkmcnt(10)
    v_mfma_f32_32x32x16_bf16 v[48:63], v[0:3], v[8:11], v[48:63]
    v_mfma_f32_32x32x16_bf16 v[64:79], v[4:7], v[8:11], v[64:79]
    ds_read_b128 v[44:47], v162 offset:224
    ds_read_b64_tr_b16 v[36:37], v163 offset:28672
    ds_read_b64_tr_b16 v[38:39], v163 offset:29696
    ds_read_b64_tr_b16 v[40:41], v163 offset:61440
    ds_read_b64_tr_b16 v[42:43], v163 offset:62464
    s_waitcnt lgkmcnt(10)
    v_mfma_f32_32x32x16_bf16 v[48:63], v[12:15], v[20:23], v[48:63]
    v_mfma_f32_32x32x16_bf16 v[64:79], v[16:19], v[20:23], v[64:79]
    s_waitcnt lgkmcnt(5)
    v_mfma_f32_32x32x16_bf16 v[48:63], v[24:27], v[32:35], v[48:63]
    v_mfma_f32_32x32x16_bf16 v[64:79], v[28:31], v[32:35], v[64:79]
    s_waitcnt lgkmcnt(0)
    v_mfma_f32_32x32x16_bf16 v[48:63], v[36:39], v[44:47], v[48:63]
    v_mfma_f32_32x32x16_bf16 v[64:79], v[40:43], v[44:47], v[64:79]
    s_mov_b32 s61, 0
    s_waitcnt vmcnt(9)
Lnonce_check:
    v_readfirstlane_b32 s74, v104
    v_readfirstlane_b32 s75, v105
    s_add_u32 s61, s61, 1
    s_cmp_lg_u32 s74, 0
    s_cbranch_scc1 Lnonce_ok
    buffer_load_dwordx2 v[104:105], v153, s[80:83], 0 offen sc1
    s_cmp_lt_u32 s61, 20000
    s_waitcnt vmcnt(0)
    s_cbranch_scc1 Lnonce_check
Lnonce_ok:
    s_and_b32 s75, s75, 0x3ff
    s_lshl_b32 s3, s75, 22
    v_lshl_or_b32 v132, v124, 11, v128
    v_lshl_or_b32 v134, v125, 11, v129
    v_or_b32 v132, s3, v132
    v_or_b32 v134, s3, v134
    v_mov_b32 v133, s74
    v_mov_b32 v135, s74
    v_lshrrev_b32 v168, 11, v150
    v_and_b32 v169, 2047, v150
    v_lshl_add_u32 v168, v168, 19, v169
    s_lshl_b32 s3, s2, 11
    s_cmp_ge_u32 s56, 2
    s_barrier
    s_cbranch_scc1 Lno_off
    buffer_store_dwordx4 v[132:135], v168, s[40:43], s3 offen sc1
Lno_off:
    v_fma_mixlo_f16 v64, v48, s63, 0
    v_fma_mixlo_f16 v65, v49, s63, 0
    v_fma_mixlo_f16 v66, v50, s63, 0
    v_fma_mixlo_f16 v67, v51, s63, 0
    ds_write_b128 v164, v[64:67] offset:0
    v_fma_mixlo_f16 v68, v52, s63, 0
    v_fma_mixlo_f16 v69, v53, s63, 0
    v_fma_mixlo_f16 v70, v54, s63, 0
    v_fma_mixlo_f16 v71, v55, s63, 0
    ds_write_b128 v164, v[68:71] offset:32
    v_fma_mixlo_f16 v72, v56, s63, 0
    v_fma_mixlo_f16 v73, v57, s63, 0
    v_fma_mixlo_f16 v74, v58, s63, 0
    v_fma_mixlo_f16 v75, v59, s63, 0
    ds_write_b128 v164, v[72:75] offset:64
    v_fma_mixlo_f16 v76, v60, s63, 0
    v_fma_mixlo_f16 v77, v61, s63, 0
    v_fma_mixlo_f16 v78, v62, s63, 0
    v_fma_mixlo_f16 v79, v63, s63, 0
    ds_write_b128 v164, v[76:79] offset:96
    ds_read_b128 v[80:83], v147 offset:0
    ds_read_b128 v[84:87], v147 offset:1152
    ds_read_b128 v[88:91], v147 offset:2304
    ds_read_b128 v[92:95], v147 offset:3456
    s_lshr_b32 s3, s2, 6
    s_or_b32 s3, s3, s56
    s_cbranch_scc1 Lno_pad
    v_mov_b32 v168, 0x7c00
    v_mov_b32 v169, 0x7c00
    v_lshrrev_b32 v170, 1, v151
    s_lshl_b32 s3, s2, 9
    s_add_u32 s3, s3, 6400000
    buffer_store_dwordx2 v[168:169], v170, s[28:31], s3 offen sc1
Lno_pad:
    s_lshr_b32 s3, s57, 8
    s_lshl_b32 s3, s3, 16
    s_and_b32 s94, s57, 255
    s_add_u32 s94, s94, s3
    s_lshl_b32 s94, s94, 3
    s_mov_b32 s3, 0
    s_waitcnt lgkmcnt(3)
    buffer_store_dwordx4 v[80:83], v165, s[44:47], s3 offen sc1
    s_add_u32 s3, s3, 4096
    s_waitcnt lgkmcnt(2)
    buffer_store_dwordx4 v[84:87], v165, s[44:47], s3 offen sc1
    s_add_u32 s3, s3, 4096
    s_waitcnt lgkmcnt(1)
    buffer_store_dwordx4 v[88:91], v165, s[44:47], s3 offen sc1
    s_add_u32 s3, s3, 4096
    s_waitcnt lgkmcnt(0)
    buffer_store_dwordx4 v[92:95], v165, s[44:47], s3 offen sc1
    s_add_u32 s3, s3, 4096
    s_cmp_ge_u32 s56, 2
    s_cbranch_scc1 Lwau_0
    s_waitcnt vmcnt(5)
    s_branch Lwau_1
Lwau_0:
    s_waitcnt vmcnt(4)
Lwau_1:
    s_barrier
    ds_read_b64_tr_b16 v[0:1], v166 offset:0
    ds_read_b64_tr_b16 v[2:3], v166 offset:1024
    ds_read_b128 v[172:175], v156 offset:0
    ds_read_b64_tr_b16 v[4:5], v166 offset:4096
    ds_read_b64_tr_b16 v[6:7], v166 offset:5120
    ds_read_b128 v[176:179], v156 offset:32
    ds_read_b64_tr_b16 v[8:9], v166 offset:8192
    ds_read_b64_tr_b16 v[10:11], v166 offset:9216
    ds_read_b128 v[180:183], v156 offset:64
    ds_read_b64_tr_b16 v[12:13], v166 offset:12288
    ds_read_b64_tr_b16 v[14:15], v166 offset:13312
    ds_read_b128 v[184:187], v156 offset:96
    buffer_load_dwordx2 v[244:245], v167, s[40:43], s94 offen sc1
    s_waitcnt lgkmcnt(9)
    v_mfma_f32_32x32x16_bf16 v[32:47], v[0:3], v[172:175], 0
    ds_read_b64_tr_b16 v[16:17], v166 offset:16384
    ds_read_b64_tr_b16 v[18:19], v166 offset:17408
    ds_read_b128 v[188:191], v156 offset:128
    s_waitcnt lgkmcnt(9)
    v_mfma_f32_32x32x16_bf16 v[32:47], v[4:7], v[176:179], v[32:47]
    ds_read_b64_tr_b16 v[20:21], v166 offset:20480
    ds_read_b64_tr_b16 v[22:23], v166 offset:21504
    ds_read_b128 v[192:195], v156 offset:160
    s_waitcnt lgkmcnt(9)
    v_mfma_f32_32x32x16_bf16 v[32:47], v[8:11], v[180:183], v[32:47]
    ds_read_b64_tr_b16 v[24:25], v166 offset:24576
    ds_read_b64_tr_b16 v[26:27], v166 offset:25600
    ds_read_b128 v[196:199], v156 offset:192
    s_waitcnt lgkmcnt(9)
    v_mfma_f32_32x32x16_bf16 v[32:47], v[12:15], v[184:187], v[32:47]
    ds_read_b64_tr_b16 v[28:29], v166 offset:28672
    ds_read_b64_tr_b16 v[30:31], v166 offset:29696
    ds_read_b128 v[200:203], v156 offset:224
    s_waitcnt lgkmcnt(9)
    v_mfma_f32_32x32x16_bf16 v[32:47], v[16:19], v[188:191], v[32:47]
    ds_read_b128 v[172:175], v156 offset:8704
    s_waitcnt lgkmcnt(7)
    v_mfma_f32_32x32x16_bf16 v[32:47], v[20:23], v[192:195], v[32:47]
    ds_read_b128 v[176:179], v156 offset:8736
    s_waitcnt lgkmcnt(5)
    v_mfma_f32_32x32x16_bf16 v[32:47], v[24:27], v[196:199], v[32:47]
    ds_read_b128 v[180:183], v156 offset:8768
    s_waitcnt lgkmcnt(3)
    v_mfma_f32_32x32x16_bf16 v[32:47], v[28:31], v[200:203], v[32:47]
    ds_read_b128 v[184:187], v156 offset:8800
    s_waitcnt lgkmcnt(3)
    v_mfma_f32_32x32x16_bf16 v[48:63], v[0:3], v[172:175], 0
    ds_read_b128 v[188:191], v156 offset:8832
    s_waitcnt lgkmcnt(3)
    v_mfma_f32_32x32x16_bf16 v[48:63], v[4:7], v[176:179], v[48:63]
    ds_read_b128 v[192:195], v156 offset:8864
    s_waitcnt lgkmcnt(3)
    v_mfma_f32_32x32x16_bf16 v[48:63], v[8:11], v[180:183], v[48:63]
    ds_read_b128 v[196:199], v156 offset:8896
    s_waitcnt lgkmcnt(3)
    v_mfma_f32_32x32x16_bf16 v[48:63], v[12:15], v[184:187], v[48:63]
    ds_read_b128 v[200:203], v156 offset:8928
    s_waitcnt lgkmcnt(3)
    v_mfma_f32_32x32x16_bf16 v[48:63], v[16:19], v[188:191], v[48:63]
    s_waitcnt lgkmcnt(2)
    v_mfma_f32_32x32x16_bf16 v[48:63], v[20:23], v[192:195], v[48:63]
    s_waitcnt lgkmcnt(1)
    v_mfma_f32_32x32x16_bf16 v[48:63], v[24:27], v[196:199], v[48:63]
    s_waitcnt lgkmcnt(0)
    v_mfma_f32_32x32x16_bf16 v[48:63], v[28:31], v[200:203], v[48:63]
    v_lshrrev_b32 v150, 1, v243
    v_and_b32 v149, 1, v243
    v_mul_u32_u24 v150, 1568, v150
    v_lshl_add_u32 v149, v149, 2, s59
    v_add_u32 v149, v149, v150
    v_lshlrev_b32 v150, 5, v150
    v_mov_b64 v[116:117], 0
    v_mov_b64 v[118:119], 0
    v_mov_b64 v[120:121], 0
    v_mov_b64 v[122:123], 0
    s_waitcnt vmcnt(1)
    s_barrier
    s_cmp_lg_u32 s56, 7
    s_cbranch_scc1 Lno_tf
    s_lshl_b32 s73, s2, 3
    s_add_u32 s73, s73, 524288
    s_mov_b64 exec, 1
    buffer_store_dwordx2 v[132:133], v153, s[40:43], s73 offen sc1
    s_mov_b64 exec, -1
    s_waitcnt vmcnt(1)
    s_branch Ltf_sent
Lno_tf:
    s_waitcnt vmcnt(0)
Ltf_sent:
    s_mov_b32 s61, 0
Loff_check:
    v_lshrrev_b32 v159, 22, v244
    v_cmp_ne_u32_e64 s[72:73], s74, v245
    v_cmp_ne_u32 vcc, s75, v159
    s_add_u32 s61, s61, 1
    s_or_b64 vcc, vcc, s[72:73]
    s_cbranch_scc0 Loff_ok
    buffer_load_dwordx2 v[244:245], v167, s[40:43], s94 offen sc1
    s_cmp_lt_u32 s61, 20000
    s_waitcnt vmcnt(0)
    s_cbranch_scc1 Loff_check
Loff_ok:
    v_and_b32 v152, 0x7ff, v244
    v_add_lshl_u32 v152, v152, v149, 2
    buffer_load_dwordx4 v[108:111], v152, s[36:39], 0 offen sc1
    v_bfe_u32 v148, v244, 11, 11
    v_and_b32 v149, 1, v243
    v_subrev_u32 v148, s59, v148
    v_lshlrev_b32 v149, 2, v149
    v_cmp_lt_i32_e64 s[70:71], 24, v148
    v_sub_u32 v148, v148, v149
    v_cmp_lt_i32_e64 s[76:77], 0, v148
    v_cmp_lt_i32_e64 s[78:79], 1, v148
    v_cmp_lt_i32_e64 s[80:81], 2, v148
    v_cmp_lt_i32_e64 s[82:83], 3, v148
    v_cmp_lt_i32_e64 s[84:85], 8, v148
    v_cmp_lt_i32_e64 s[86:87], 9, v148
    v_cmp_lt_i32_e64 s[88:89], 10, v148
    v_cmp_lt_i32_e64 s[90:91], 11, v148
    v_cmp_lt_i32_e64 s[18:19], 16, v148
    v_cmp_lt_i32_e64 s[20:21], 17, v148
    v_cmp_lt_i32_e64 s[22:23], 18, v148
    v_cmp_lt_i32_e64 s[24:25], 19, v148
    s_mov_b64 exec, s[84:85]
    s_cbranch_execz Lno_rec1
    buffer_load_dwordx4 v[112:115], v152, s[36:39], 0 offen offset:32 sc1
Lno_rec1:
    s_mov_b64 exec, -1
    s_cmp_eq_u64 s[18:19], 0
    s_cbranch_scc1 Lno_rec2
    buffer_load_dwordx4 v[220:223], v152, s[36:39], 0 offen offset:64 sc1
    v_mov_b64 v[224:225], 0
    v_mov_b64 v[226:227], 0
Lno_rec2:
    s_cmp_lt_u32 s56, 4
    s_cbranch_scc1 Lno_ident
    s_and_b32 s3, s56, 3
    s_lshl_b32 s3, s3, 6
    v_add_u32 v159, s3, v156
    ds_read_b128 v[172:175], v159 offset:0
    ds_read_b128 v[176:179], v159 offset:32
    ds_read_b128 v[180:183], v159 offset:8704
    ds_read_b128 v[184:187], v159 offset:8736
    v_lshrrev_b32 v159, 4, v236
    v_lshrrev_b32 v160, 1, v241
    v_sub_u32 v159, v159, v160
    v_and_b32 v160, 1, v159
    v_lshlrev_b32 v160, 4, v160
    v_mov_b32 v161, 0x3f80
    v_lshlrev_b32 v160, v160, v161
    v_ashrrev_i32 v159, 1, v159
    v_cmp_eq_u32_e64 s[72:73], 0, v159
    v_cmp_eq_u32_e64 s[68:69], 1, v159
    s_nop 0
    v_cndmask_b32_e64 v64, 0, v160, s[72:73]
    v_cmp_eq_u32_e64 s[72:73], 2, v159
    s_nop 0
    v_cndmask_b32_e64 v65, 0, v160, s[68:69]
    v_cmp_eq_u32_e64 s[68:69], 3, v159
    s_nop 0
    v_cndmask_b32_e64 v66, 0, v160, s[72:73]
    v_cmp_eq_u32_e64 s[72:73], 8, v159
    s_nop 0
    v_cndmask_b32_e64 v67, 0, v160, s[68:69]
    v_cmp_eq_u32_e64 s[68:69], 9, v159
    s_nop 0
    v_cndmask_b32_e64 v68, 0, v160, s[72:73]
    v_cmp_eq_u32_e64 s[72:73], 10, v159
    s_nop 0
    v_cndmask_b32_e64 v69, 0, v160, s[68:69]
    v_cmp_eq_u32_e64 s[68:69], 11, v159
    s_nop 0
    v_cndmask_b32_e64 v70, 0, v160, s[72:73]
    s_nop 0
    v_cndmask_b32_e64 v71, 0, v160, s[68:69]
    s_waitcnt lgkmcnt(0)
    v_mfma_f32_32x32x16_bf16 v[32:47], v[64:67], v[172:175], v[32:47]
    v_mfma_f32_32x32x16_bf16 v[48:63], v[64:67], v[180:183], v[48:63]
    v_mfma_f32_32x32x16_bf16 v[32:47], v[68:71], v[176:179], v[32:47]
    v_mfma_f32_32x32x16_bf16 v[48:63], v[68:71], v[184:187], v[48:63]
Lno_ident:
    v_lshrrev_b32 v167, 1, v236
    s_lshl_b32 s49, s56, 8
    s_add_u32 s49, s49, 524288
    s_mov_b64 vcc, s[70:71]
    s_cmp_ge_u32 s56, 4
    s_cbranch_scc1 Lu_wave
    v_mov_b32 v98, 0
    v_max3_f32 v98, |v32|, |v33|, v98
    v_max3_f32 v98, |v34|, |v35|, v98
    v_max3_f32 v98, |v36|, |v37|, v98
    v_max3_f32 v98, |v38|, |v39|, v98
    v_max3_f32 v98, |v40|, |v41|, v98
    v_max3_f32 v98, |v42|, |v43|, v98
    v_max3_f32 v98, |v44|, |v45|, v98
    v_max3_f32 v98, |v46|, |v47|, v98
    s_mov_b32 exec_lo, 0xfffff
    s_mov_b32 exec_hi, 0xfffff
    v_max3_f32 v98, |v48|, |v49|, v98
    v_max3_f32 v98, |v50|, |v51|, v98
    v_max3_f32 v98, |v52|, |v53|, v98
    v_max3_f32 v98, |v54|, |v55|, v98
    v_max3_f32 v98, |v56|, |v57|, v98
    v_max3_f32 v98, |v58|, |v59|, v98
    v_max3_f32 v98, |v60|, |v61|, v98
    v_max3_f32 v98, |v62|, |v63|, v98
    s_mov_b64 exec, -1
    v_cmp_lt_f32 vcc, 0x42500000, v98
    s_or_b64 vcc, vcc, s[70:71]
Lu_wave:
    s_mov_b64 exec, vcc
    ds_write_b32 v153, v154 offset:4096
    s_mov_b64 exec, -1
    s_mul_i32 s62, s56, 2560
    s_add_u32 s62, s62, 29696
    v_add_u32 v238, s62, v241
    v_bfe_u32 v160, v243, 3, 2
    v_bfe_u32 v161, v243, 1, 1
    v_lshl_add_u32 v160, v160, 1, v161
    v_bfe_u32 v161, v243, 2, 1
    v_lshl_add_u32 v160, v160, 1, v161
    v_and_b32 v161, 1, v243
    v_lshl_add_u32 v160, v160, 1, v161
    v_lshl_add_u32 v239, v160, 2, s62
    v_bfrev_b32 v161, 2
    v_and_b32 v160, 63, v243
    v_add_u32 v160, 12500, v160
    v_lshlrev_b32 v160, 18, v160
    v_lshlrev_b32 v132, 1, v151
    v_lshlrev_b32 v133, 3, v151
    v_lshrrev_b32 v134, 4, v151
    v_lshl_add_u32 v135, v134, 2, s62
    s_waitcnt vmcnt(0)
    s_mov_b64 exec, s[76:77]
    v_alignbit_b32 v116, v108, v108, 27
    v_and_b32 v116, 0x7fc, v116
    ds_add_rtn_u32 v124, v116, v154 offset:0
    s_mov_b64 exec, s[78:79]
    v_alignbit_b32 v117, v109, v109, 27
    v_and_b32 v117, 0x7fc, v117
    ds_add_rtn_u32 v125, v117, v154 offset:0
    s_mov_b64 exec, s[80:81]
    v_alignbit_b32 v118, v110, v110, 27
    v_and_b32 v118, 0x7fc, v118
    ds_add_rtn_u32 v126, v118, v154 offset:0
    s_mov_b64 exec, s[82:83]
    v_alignbit_b32 v119, v111, v111, 27
    v_and_b32 v119, 0x7fc, v119
    ds_add_rtn_u32 v127, v119, v154 offset:0
    s_mov_b64 exec, s[84:85]
    v_alignbit_b32 v120, v112, v112, 27
    v_and_b32 v120, 0x7fc, v120
    ds_add_rtn_u32 v128, v120, v154 offset:0
    s_mov_b64 exec, s[86:87]
    v_alignbit_b32 v121, v113, v113, 27
    v_and_b32 v121, 0x7fc, v121
    ds_add_rtn_u32 v129, v121, v154 offset:0
    s_mov_b64 exec, s[88:89]
    v_alignbit_b32 v122, v114, v114, 27
    v_and_b32 v122, 0x7fc, v122
    ds_add_rtn_u32 v130, v122, v154 offset:0
    s_mov_b64 exec, s[90:91]
    v_alignbit_b32 v123, v115, v115, 27
    v_and_b32 v123, 0x7fc, v123
    ds_add_rtn_u32 v131, v123, v154 offset:0
    s_mov_b64 exec, -1
    s_cmp_eq_u64 s[18:19], 0
    s_cbranch_scc1 Lno_hist2
    s_mov_b64 exec, s[18:19]
    v_alignbit_b32 v224, v220, v220, 27
    v_and_b32 v224, 0x7fc, v224
    ds_add_rtn_u32 v228, v224, v154 offset:0
    s_mov_b64 exec, s[20:21]
    v_alignbit_b32 v225, v221, v221, 27
    v_and_b32 v225, 0x7fc, v225
    ds_add_rtn_u32 v229, v225, v154 offset:0
    s_mov_b64 exec, s[22:23]
    v_alignbit_b32 v226, v222, v222, 27
    v_and_b32 v226, 0x7fc, v226
    ds_add_rtn_u32 v230, v226, v154 offset:0
    s_mov_b64 exec, s[24:25]
    v_alignbit_b32 v227, v223, v223, 27
    v_and_b32 v227, 0x7fc, v227
    ds_add_rtn_u32 v231, v227, v154 offset:0
    s_mov_b64 exec, -1
Lno_hist2:
    buffer_load_dwordx2 v[106:107], v167, s[40:43], s49 offen sc1
    s_mov_b32 s3, 576716800
    v_cmp_gt_u32 vcc, s3, v108
    v_bfe_u32 v140, v108, 6, 12
    v_lshl_add_u32 v140, v140, 5, v150
    s_and_b64 vcc, vcc, s[76:77]
    s_or_b64 exec, vcc, 1
    buffer_load_dword v194, v140, s[32:35], 0 offen
    s_mov_b64 exec, -1
    v_cmp_gt_u32 vcc, s3, v109
    v_bfe_u32 v141, v109, 6, 12
    v_lshl_add_u32 v141, v141, 5, v150
    s_and_b64 vcc, vcc, s[78:79]
    s_or_b64 exec, vcc, 1
    buffer_load_dword v194, v141, s[32:35], 0 offen
    s_mov_b64 exec, -1
    v_cmp_gt_u32 vcc, s3, v110
    v_bfe_u32 v142, v110, 6, 12
    v_lshl_add_u32 v142, v142, 5, v150
    s_and_b64 vcc, vcc, s[80:81]
    s_or_b64 exec, vcc, 1
    buffer_load_dword v194, v142, s[32:35], 0 offen
    s_mov_b64 exec, -1
    v_cmp_gt_u32 vcc, s3, v111
    v_bfe_u32 v143, v111, 6, 12
    v_lshl_add_u32 v143, v143, 5, v150
    s_and_b64 vcc, vcc, s[82:83]
    s_or_b64 exec, vcc, 1
    buffer_load_dword v194, v143, s[32:35], 0 offen
    s_mov_b64 exec, -1
    s_waitcnt lgkmcnt(0)
    s_barrier
    ds_read_b128 v[172:175], v132 offset:0
    ds_read_b128 v[176:179], v132 offset:16
    s_mov_b32 s95, 12800
    s_waitcnt lgkmcnt(1)
    v_add_u32 v182, v172, v173
    v_add3_u32 v184, v182, v174, v175
    s_waitcnt lgkmcnt(0)
    v_add3_u32 v186, v184, v176, v177
    v_add3_u32 v188, v186, v178, v179
    v_add_u32 v189, 3, v188
    v_lshrrev_b32 v190, 2, v189
    v_lshrrev_b32 v189, 2, v189
    v_add_u32 v183, v182, v174
    v_add_u32_dpp v190, v190, v190 row_shr:1 row_mask:0xf bank_mask:0xf
    v_add_u32 v185, v184, v176
    v_add_u32 v187, v186, v178
    v_add_u32_dpp v190, v190, v190 row_shr:2 row_mask:0xf bank_mask:0xf
    v_mad_i32_i24 v174, v188, -8, s95
    v_lshlrev_b32 v173, 2, v189
    v_add_u32_dpp v190, v190, v190 row_shr:4 row_mask:0xf bank_mask:0xf
    v_add_u32 v188, s56, v188
    s_lshl_b32 s96, s56, 3
    v_add_u32_dpp v190, v190, v190 row_shr:8 row_mask:0xf bank_mask:0xf
    v_cmp_lt_u32_e64 s[68:69], v188, v173
    s_add_u32 s96, s96, 8
    v_add_u32_dpp v190, v190, v190 row_bcast:15 row_mask:0xa bank_mask:0xf
    s_nop 1
    v_add_u32_dpp v190, v190, v190 row_bcast:31 row_mask:0xc bank_mask:0xf
    v_sub_u32 v191, v190, v189
    v_readlane_b32 s3, v190, 63
    v_lshl_add_u32 v180, v190, 5, v174
    v_lshl_add_u32 v181, v172, 3, v180
    v_lshl_add_u32 v182, v182, 3, v180
    v_lshl_add_u32 v183, v183, 3, v180
    ds_write_b128 v132, v[180:183] offset:2048
    v_lshl_add_u32 v184, v184, 3, v180
    v_lshl_add_u32 v185, v185, 3, v180
    v_lshl_add_u32 v186, v186, 3, v180
    v_lshl_add_u32 v187, v187, 3, v180
    ds_write_b128 v132, v[184:187] offset:2064
    ds_read_b32 v116, v116 offset:2048
    ds_read_b32 v117, v117 offset:2048
    ds_read_b32 v118, v118 offset:2048
    ds_read_b32 v119, v119 offset:2048
    ds_read_b32 v120, v120 offset:2048
    ds_read_b32 v121, v121 offset:2048
    ds_read_b32 v122, v122 offset:2048
    ds_read_b32 v123, v123 offset:2048
    s_mul_i32 s97, s3, s56
    s_add_u32 s60, s97, s3
    s_lshr_b32 s97, s97, 3
    s_lshr_b32 s60, s60, 3
    v_cmp_gt_u32_e64 s[72:73], s97, v191
    v_cmp_gt_u32 vcc, s60, v191
    v_subrev_u32 v188, s96, v180
    s_bcnt1_i32_b64 s98, s[72:73]
    s_bcnt1_i32_b64 s99, vcc
    s_cmp_eq_u32 s56, 7
    s_cselect_b32 s99, s0, s99
    s_sub_u32 s99, s99, s98
    s_sub_u32 s60, s60, s97
    s_waitcnt lgkmcnt(0)
    s_mov_b64 exec, s[76:77]
    v_lshl_add_u32 v116, v124, 3, v116
    ds_write2_b32 v116, v108, v150 offset0:0 offset1:1
    s_mov_b64 exec, s[78:79]
    v_lshl_add_u32 v117, v125, 3, v117
    ds_write2_b32 v117, v109, v150 offset0:0 offset1:1
    s_mov_b64 exec, s[80:81]
    v_lshl_add_u32 v118, v126, 3, v118
    ds_write2_b32 v118, v110, v150 offset0:0 offset1:1
    s_mov_b64 exec, s[82:83]
    v_lshl_add_u32 v119, v127, 3, v119
    ds_write2_b32 v119, v111, v150 offset0:0 offset1:1
    s_mov_b64 exec, s[84:85]
    v_lshl_add_u32 v120, v128, 3, v120
    ds_write2_b32 v120, v112, v150 offset0:0 offset1:1
    s_mov_b64 exec, s[86:87]
    v_lshl_add_u32 v121, v129, 3, v121
    ds_write2_b32 v121, v113, v150 offset0:0 offset1:1
    s_mov_b64 exec, s[88:89]
    v_lshl_add_u32 v122, v130, 3, v122
    ds_write2_b32 v122, v114, v150 offset0:0 offset1:1
    s_mov_b64 exec, s[90:91]
    v_lshl_add_u32 v123, v131, 3, v123
    ds_write2_b32 v123, v115, v150 offset0:0 offset1:1
    s_mov_b64 exec, -1
    s_cmp_eq_u64 s[18:19], 0
    s_cbranch_scc1 Lno_place2
    ds_read_b32 v224, v224 offset:2048
    ds_read_b32 v225, v225 offset:2048
    ds_read_b32 v226, v226 offset:2048
    ds_read_b32 v227, v227 offset:2048
    s_waitcnt lgkmcnt(0)
    s_mov_b64 exec, s[18:19]
    v_lshl_add_u32 v224, v228, 3, v224
    ds_write2_b32 v224, v220, v150 offset0:0 offset1:1
    s_mov_b64 exec, s[20:21]
    v_lshl_add_u32 v225, v229, 3, v225
    ds_write2_b32 v225, v221, v150 offset0:0 offset1:1
    s_mov_b64 exec, s[22:23]
    v_lshl_add_u32 v226, v230, 3, v226
    ds_write2_b32 v226, v222, v150 offset0:0 offset1:1
    s_mov_b64 exec, s[24:25]
    v_lshl_add_u32 v227, v231, 3, v227
    ds_write2_b32 v227, v223, v150 offset0:0 offset1:1
    s_mov_b64 exec, -1
Lno_place2:
    s_mov_b64 exec, s[68:69]
    ds_write_b64 v188, v[160:161]
    s_mov_b64 exec, -1
    s_waitcnt vmcnt(4)
    s_mov_b32 s61, 0
Ltf_check:
    v_lshrrev_b32 v159, 22, v106
    v_cmp_ne_u32_e64 s[72:73], s74, v107
    v_cmp_ne_u32 vcc, s75, v159
    s_add_u32 s61, s61, 1
    s_or_b64 vcc, vcc, s[72:73]
    s_cbranch_scc0 Ltf_ok
    buffer_load_dwordx2 v[106:107], v167, s[40:43], s49 offen sc1
    s_cmp_lt_u32 s61, 20000
    s_waitcnt vmcnt(0)
    s_cbranch_scc1 Ltf_check
Ltf_ok:
    s_sub_u32 s3, s99, 1
    s_sub_u32 s72, s60, 1
    s_cmp_gt_u32 s72, 63
    s_cselect_b32 s3, 8, s3
    s_cmp_gt_u32 s3, 7
    s_cselect_b64 exec, 1, 0
    ds_write_b32 v153, v154 offset:4096
    s_mov_b64 exec, -1
    s_lshl_b32 s3, s97, 5
    v_add_u32 v198, s3, v132
    v_cmp_le_u32_e64 s[72:73], s60, v134
    s_sub_u32 s94, s98, 1
    s_mul_i32 s95, s94, 528
    s_add_u32 s95, s95, 97296
    s_mov_b32 s96, 4294966784
    s_waitcnt lgkmcnt(0)
    s_barrier
    ds_read_b128 v[172:175], v198 offset:12800
    ds_read_b32 v201, v153 offset:4096
    ds_read_b128 v[176:179], v198 offset:12816
    v_cndmask_b32_e64 v158, 0, v161, s[72:73]
    v_add_u32 v246, s95, v236
    v_mov_b64 v[196:197], 1
    s_waitcnt lgkmcnt(0)
    v_min_u32 v192, v176, v178
    v_lshrrev_b32 v192, 26, v192
    v_and_b32 v192, 56, v192
    v_cndmask_b32_e64 v192, v192, 56, s[72:73]
    s_waitcnt lgkmcnt(1)
    v_readfirstlane_b32 s3, v201
    v_lshlrev_b64 v[196:197], v192, v[196:197]
    v_and_b32 v201, 63, v178
    s_cmp_lg_u32 s3, 0
    s_cbranch_scc1 Lslow_entry
    s_waitcnt lgkmcnt(0)
    v_add_u32_dpp v196, v196, v196 row_shr:1 row_mask:0xf bank_mask:0xf
    v_add_u32_dpp v197, v197, v197 row_shr:1 row_mask:0xf bank_mask:0xf
    v_subrev_u32 v201, s94, v201
    v_add_u32_dpp v196, v196, v196 row_shr:2 row_mask:0xf bank_mask:0xf
    v_add_u32_dpp v197, v197, v197 row_shr:2 row_mask:0xf bank_mask:0xf
    v_mul_u32_u24 v201, 12, v201
    v_add_u32_dpp v196, v196, v196 row_shr:4 row_mask:0xf bank_mask:0xf
    v_add_u32_dpp v197, v197, v197 row_shr:4 row_mask:0xf bank_mask:0xf
    v_lshrrev_b32 v180, 9, v172
    v_add_u32_dpp v196, v196, v196 row_shr:8 row_mask:0xf bank_mask:0xf
    v_add_u32_dpp v197, v197, v197 row_shr:8 row_mask:0xf bank_mask:0xf
    v_lshrrev_b32 v181, 9, v174
    v_add_u32_dpp v196, v196, v196 row_bcast:15 row_mask:0xa bank_mask:0xf
    v_add_u32_dpp v197, v197, v197 row_bcast:15 row_mask:0xa bank_mask:0xf
    v_lshrrev_b32 v182, 9, v176
    v_add_u32_dpp v196, v196, v196 row_bcast:31 row_mask:0xc bank_mask:0xf
    v_add_u32_dpp v197, v197, v197 row_bcast:31 row_mask:0xc bank_mask:0xf
    v_lshrrev_b32 v183, 9, v178
    v_readlane_b32 s72, v196, 63
    v_readlane_b32 s73, v197, 63
    v_bfe_u32 v184, v172, 6, 12
    v_bfe_u32 v185, v174, 6, 12
    v_bfe_u32 v186, v176, 6, 12
    v_bfe_u32 v187, v178, 6, 12
    s_mul_i32 s3, s72, 0x01010101
    s_mul_i32 s73, s73, 0x01010100
    s_lshl_b32 s72, s3, 8
    s_lshr_b32 s3, s3, 24
    s_mul_i32 s3, s3, 0x01010101
    s_add_u32 s73, s73, s3
    v_lshl_add_u64 v[196:197], v[196:197], 0, s[72:73]
    s_sub_u32 s3, s62, 16
    v_lshrrev_b64 v[196:197], v192, v[196:197]
    v_lshl_add_u32 v184, v184, 5, v173
    v_lshl_add_u32 v185, v185, 5, v175
    v_lshl_add_u32 v186, v186, 5, v177
    v_lshl_add_u32 v187, v187, 5, v179
    v_and_b32 v193, 0xff, v196
    v_or_b32 v184, v184, v158
    v_or_b32 v185, v185, v158
    v_or_b32 v186, v186, v158
    v_or_b32 v187, v187, v158
    v_lshl_add_u32 v198, v193, 4, s3
    ds_write_b128 v198, v[184:187] offset:1152
    ds_read_b32 v240, v239 offset:1152
    v_and_or_b32 v180, v180, s96, v158
    v_and_or_b32 v181, v181, s96, v158
    v_and_or_b32 v182, v182, s96, v158
    v_and_or_b32 v183, v183, s96, v158
    v_and_b32 v199, 1, v193
    v_lshl_add_u32 v199, v199, 3, v198
    v_subrev_u32 v199, 8, v199
    ds_write2_b64 v199, v[180:181], v[182:183] offset0:0 offset1:2
    ds_read_b128 v[224:227], v238
    ds_read_b128 v[232:235], v238 offset:32
    v_add_u32 v200, s62, v193
    ds_write_b8 v200, v201 offset:2303
    ds_read_b32 v242, v135 offset:2304
    s_waitcnt lgkmcnt(5)
    v_add_u32 v240, v240, v241
    buffer_load_dwordx4 v[220:223], v240, s[32:35], 0 offen
    s_waitcnt lgkmcnt(3)
    v_lshl_add_u64 v[224:225], v[224:225], 0, v[236:237]
    buffer_load_dwordx4 v[172:175], v224, s[28:31], 0 offen sc1
    buffer_load_dwordx4 v[176:179], v225, s[28:31], 0 offen sc1
    v_lshl_add_u64 v[226:227], v[226:227], 0, v[236:237]
    buffer_load_dwordx4 v[180:183], v226, s[28:31], 0 offen sc1
    buffer_load_dwordx4 v[184:187], v227, s[28:31], 0 offen sc1
    s_waitcnt lgkmcnt(1)
    v_lshl_add_u64 v[232:233], v[232:233], 0, v[236:237]
    buffer_load_dwordx4 v[188:191], v232, s[28:31], 0 offen sc1
    buffer_load_dwordx4 v[192:195], v233, s[28:31], 0 offen sc1
    v_lshl_add_u64 v[234:235], v[234:235], 0, v[236:237]
    buffer_load_dwordx4 v[196:199], v234, s[28:31], 0 offen sc1
    buffer_load_dwordx4 v[200:203], v235, s[28:31], 0 offen sc1
    v_lshrrev_b32 v159, 1, v236
    v_lshl_add_u32 v159, v241, 7, v159
    v_add_u32 v159, 78336, v159
    ds_read_b64 v[108:109], v159 offset:0
    ds_read_b64 v[110:111], v159 offset:256
    ds_read_b64 v[112:113], v159 offset:512
    ds_read_b64 v[114:115], v159 offset:768
    ds_read_b64 v[116:117], v159 offset:1024
    ds_read_b64 v[118:119], v159 offset:1280
    ds_read_b64 v[120:121], v159 offset:1536
    ds_read_b64 v[122:123], v159 offset:1792
    s_and_b32 s3, s56, 4
    v_mov_b32 v247, s3
    s_cbranch_scc1 Lfactors_made
    v_mov_b32 v96, 0xc2400000
    v_mov_b32 v97, 0xc2400000
    s_mov_b32 s72, s63
    s_mov_b32 s73, s63
    v_pk_fma_f32 v[32:33], v[32:33], s[72:73], v[96:97]
    v_pk_fma_f32 v[34:35], v[34:35], s[72:73], v[96:97]
    v_pk_fma_f32 v[36:37], v[36:37], s[72:73], v[96:97]
    v_pk_fma_f32 v[38:39], v[38:39], s[72:73], v[96:97]
    v_pk_fma_f32 v[40:41], v[40:41], s[72:73], v[96:97]
    v_pk_fma_f32 v[42:43], v[42:43], s[72:73], v[96:97]
    v_pk_fma_f32 v[44:45], v[44:45], s[72:73], v[96:97]
    v_pk_fma_f32 v[46:47], v[46:47], s[72:73], v[96:97]
    v_pk_fma_f32 v[48:49], v[48:49], s[72:73], v[96:97]
    v_pk_fma_f32 v[50:51], v[50:51], s[72:73], v[96:97]
    v_pk_fma_f32 v[52:53], v[52:53], s[72:73], v[96:97]
    v_pk_fma_f32 v[54:55], v[54:55], s[72:73], v[96:97]
    v_pk_fma_f32 v[56:57], v[56:57], s[72:73], v[96:97]
    v_pk_fma_f32 v[58:59], v[58:59], s[72:73], v[96:97]
    v_pk_fma_f32 v[60:61], v[60:61], s[72:73], v[96:97]
    v_pk_fma_f32 v[62:63], v[62:63], s[72:73], v[96:97]
    v_exp_f32 v32, v32
    v_exp_f32 v33, v33
    v_exp_f32 v34, v34
    v_exp_f32 v35, v35
    v_exp_f32 v36, v36
    v_exp_f32 v37, v37
    v_exp_f32 v38, v38
    v_exp_f32 v39, v39
    v_exp_f32 v40, v40
    v_exp_f32 v41, v41
    v_exp_f32 v42, v42
    v_exp_f32 v43, v43
    v_exp_f32 v44, v44
    v_exp_f32 v45, v45
    v_exp_f32 v46, v46
    v_exp_f32 v47, v47
    v_exp_f32 v48, v48
    v_exp_f32 v49, v49
    v_exp_f32 v50, v50
    v_exp_f32 v51, v51
    v_exp_f32 v52, v52
    v_exp_f32 v53, v53
    v_exp_f32 v54, v54
    v_exp_f32 v55, v55
    v_exp_f32 v56, v56
    v_exp_f32 v57, v57
    v_exp_f32 v58, v58
    v_exp_f32 v59, v59
    v_exp_f32 v60, v60
    v_exp_f32 v61, v61
    v_exp_f32 v62, v62
    v_exp_f32 v63, v63
Lfactors_made:
    ds_write_b128 v157, v[32:35] offset:0
    ds_write_b128 v157, v[36:39] offset:32
    ds_write_b128 v157, v[40:43] offset:64
    ds_write_b128 v157, v[44:47] offset:96
    s_mov_b32 exec_lo, 0xfffff
    s_mov_b32 exec_hi, 0xfffff
    ds_write_b128 v157, v[48:51] offset:16896
    ds_write_b128 v157, v[52:55] offset:16928
    ds_write_b128 v157, v[56:59] offset:16960
    ds_write_b128 v157, v[60:63] offset:16992
    s_mov_b64 exec, -1
    s_mov_b64 exec, 1
    ds_add_u32 v247, v154 offset:4104
    s_mov_b64 exec, -1
    s_waitcnt lgkmcnt(9)
    s_mov_b32 s3, 0x05040100
    s_mov_b32 s72, 0x07060302
    v_perm_b32 v204, v110, v108, s3
    v_perm_b32 v205, v114, v112, s3
    v_perm_b32 v206, v118, v116, s3
    v_perm_b32 v207, v122, v120, s3
    v_perm_b32 v208, v110, v108, s72
    v_perm_b32 v209, v114, v112, s72
    v_perm_b32 v210, v118, v116, s72
    v_perm_b32 v211, v122, v120, s72
    v_perm_b32 v212, v111, v109, s3
    v_perm_b32 v213, v115, v113, s3
    v_perm_b32 v214, v119, v117, s3
    v_perm_b32 v215, v123, v121, s3
    v_perm_b32 v216, v111, v109, s72
    v_perm_b32 v217, v115, v113, s72
    v_perm_b32 v218, v119, v117, s72
    v_perm_b32 v219, v123, v121, s72
    s_waitcnt lgkmcnt(0)
    s_mov_b32 s72, 0x4d0637bd
    s_mov_b32 s73, 0x4d0637bd
    v_mov_b64 v[0:1], 0
    v_mov_b64 v[2:3], 0
    v_mov_b64 v[4:5], 0
    v_mov_b64 v[6:7], 0
    v_mov_b64 v[12:13], 0
    v_mov_b64 v[14:15], 0
    v_mov_b64 v[16:17], s[72:73]
    v_mov_b64 v[18:19], s[72:73]
    v_mov_b64 v[24:25], 0
    v_mov_b64 v[26:27], 0
    v_mov_b64 v[28:29], s[72:73]
    v_mov_b64 v[30:31], s[72:73]
    v_mov_b64 v[36:37], 0
    v_mov_b64 v[38:39], 0
    v_mov_b64 v[40:41], s[72:73]
    v_mov_b64 v[42:43], s[72:73]
    v_mov_b64 v[48:49], 0
    v_mov_b64 v[50:51], 0
    v_mov_b64 v[52:53], s[72:73]
    v_mov_b64 v[54:55], s[72:73]
    v_mov_b64 v[60:61], 0
    v_mov_b64 v[62:63], 0
    v_mov_b64 v[64:65], s[72:73]
    v_mov_b64 v[66:67], s[72:73]
    v_mov_b64 v[72:73], 0
    v_mov_b64 v[74:75], 0
    v_mov_b64 v[76:77], s[72:73]
    v_mov_b64 v[78:79], s[72:73]
    v_mov_b64 v[84:85], 0
    v_mov_b64 v[86:87], 0
    v_mov_b64 v[88:89], s[72:73]
    v_mov_b64 v[90:91], s[72:73]
    v_mov_b64 v[96:97], 0
    v_mov_b64 v[98:99], 0
    v_mov_b64 v[100:101], s[72:73]
    v_mov_b64 v[102:103], s[72:73]
    v_add_u32 v248, s62, v151
    s_mul_i32 s3, s98, 528
    s_add_u32 s3, s3, 124752
    v_mul_u32_u24 v249, 33, v241
    v_add3_u32 v249, v249, v236, s3
    s_mul_i32 s3, s98, 272
    s_add_u32 s3, s3, 82432
    v_mul_u32_u24 v250, 17, v241
    v_lshrrev_b32 v251, 1, v236
    v_add3_u32 v250, v250, v251, s3
    v_lshl_add_u32 v251, v241, 4, v251
    s_lshl_b32 s3, s56, 2
    v_mov_b32 v252, s3
    v_mov_b32 v253, 4108
    s_add_u32 s92, s58, s98
    s_lshl_b32 s92, s92, 8
    s_mul_i32 s93, s99, 12
Lfactors:
    ds_read_b32 v247, v153 offset:4104
    ds_read_b128 v[8:11], v246 offset:0
    ds_read_b128 v[20:23], v246 offset:528
    ds_read_b128 v[32:35], v246 offset:1056
    ds_read_b128 v[44:47], v246 offset:1584
    ds_read_b128 v[56:59], v246 offset:2112
    ds_read_b128 v[68:71], v246 offset:2640
    ds_read_b128 v[80:83], v246 offset:3168
    ds_read_b128 v[92:95], v246 offset:3696
    ds_read_b128 v[104:107], v246 offset:4224
    s_waitcnt lgkmcnt(0)
    v_cmp_gt_u32 vcc, 4, v247
    s_cbranch_vccnz Lfactors
    s_waitcnt lgkmcnt(0)
    v_readlane_b32 s66, v242, 0
    v_readlane_b32 s67, v242, 1
    s_mov_b32 s68, 2
    s_mov_b32 s69, 3
    s_cmp_lt_u32 s56, 4
    s_cselect_b32 s3, 8, 16
    s_sub_i32 s94, s60, s3
    s_sub_i32 s95, s94, 16
    s_sub_i32 s96, s95, 16
    s_setprio 3
    s_waitcnt vmcnt(8)
    v_mfma_f32_32x32x16_bf16 v[108:123], v[220:223], v[204:207], 0
    v_mfma_f32_32x32x16_bf16 v[124:139], v[220:223], v[208:211], 0
    v_mfma_f32_32x32x16_bf16 v[140:155], v[220:223], v[212:215], 0
    v_mfma_f32_32x32x16_bf16 v[156:171], v[220:223], v[216:219], 0
    s_nop 8
    s_cmp_gt_u32 s60, 8
    s_cbranch_scc0 Llast
    .p2align 6
Ltile:
    s_sub_u32 s60, s60, 8
    s_waitcnt vmcnt(6)
    ds_read_b128 v[232:235], v238 offset:64
    v_fma_mix_f32 v224, v108, s63, v172 op_sel_hi:[0,0,1]
    v_fma_mix_f32 v225, v124, s63, v173 op_sel_hi:[0,0,1]
    v_fma_mix_f32 v226, v140, s63, v174 op_sel_hi:[0,0,1]
    v_fma_mix_f32 v227, v156, s63, v175 op_sel_hi:[0,0,1]
    v_fma_mix_f32 v228, v109, s63, v176 op_sel_hi:[0,0,1]
    v_fma_mix_f32 v229, v125, s63, v177 op_sel_hi:[0,0,1]
    v_fma_mix_f32 v230, v141, s63, v178 op_sel_hi:[0,0,1]
    v_fma_mix_f32 v231, v157, s63, v179 op_sel_hi:[0,0,1]
    v_exp_f32 v224, v224
    v_exp_f32 v225, v225
    v_exp_f32 v226, v226
    v_exp_f32 v227, v227
    v_exp_f32 v228, v228
    v_exp_f32 v229, v229
    v_exp_f32 v230, v230
    v_exp_f32 v231, v231
    s_waitcnt lgkmcnt(0)
    s_set_gpr_idx_on s66, gpr_idx(SRC1)
    v_pk_fma_f32 v[224:225], v[224:225], v[8:9], s[64:65] clamp
    v_pk_fma_f32 v[226:227], v[226:227], v[10:11], s[64:65] clamp
    v_pk_fma_f32 v[228:229], v[228:229], v[8:9], s[64:65] clamp
    v_pk_fma_f32 v[230:231], v[230:231], v[10:11], s[64:65] clamp
    s_set_gpr_idx_mode gpr_idx()
    s_lshr_b32 s66, s66, 8
    v_pk_mul_f32 v[172:173], v[172:173], v[228:229]
    v_pk_mul_f32 v[174:175], v[174:175], v[230:231]
    v_lshl_add_u64 v[232:233], v[232:233], 0, v[236:237]
    v_pk_fma_f32 v[172:173], v[176:177], v[224:225], v[172:173]
    v_pk_fma_f32 v[174:175], v[178:179], v[226:227], v[174:175]
    v_pk_add_f32 v[176:177], v[224:225], v[228:229]
    v_pk_add_f32 v[178:179], v[226:227], v[230:231]
    v_pk_mul_f32 v[224:225], v[224:225], v[228:229]
    v_pk_mul_f32 v[226:227], v[226:227], v[230:231]
    v_rcp_f32_e64 v224, v224
    v_rcp_f32 v225, v225
    v_rcp_f32 v226, v226
    v_rcp_f32 v227, v227
    s_set_gpr_idx_mode gpr_idx(SRC2,DST)
    v_pk_fma_f32 v[0:1], v[172:173], v[224:225], v[0:1]
    v_pk_fma_f32 v[4:5], v[176:177], v[224:225], v[4:5]
    v_pk_fma_f32 v[2:3], v[174:175], v[226:227], v[2:3]
    v_pk_fma_f32 v[6:7], v[178:179], v[226:227], v[6:7]
    buffer_load_dwordx4 v[172:175], v232, s[28:31], 0 offen sc1
    buffer_load_dwordx4 v[176:179], v233, s[28:31], 0 offen sc1
    s_set_gpr_idx_off
    s_waitcnt vmcnt(6)
    v_fma_mix_f32 v224, v110, s63, v180 op_sel_hi:[0,0,1]
    v_fma_mix_f32 v225, v126, s63, v181 op_sel_hi:[0,0,1]
    v_fma_mix_f32 v226, v142, s63, v182 op_sel_hi:[0,0,1]
    v_fma_mix_f32 v227, v158, s63, v183 op_sel_hi:[0,0,1]
    v_fma_mix_f32 v228, v111, s63, v184 op_sel_hi:[0,0,1]
    v_fma_mix_f32 v229, v127, s63, v185 op_sel_hi:[0,0,1]
    v_fma_mix_f32 v230, v143, s63, v186 op_sel_hi:[0,0,1]
    v_fma_mix_f32 v231, v159, s63, v187 op_sel_hi:[0,0,1]
    v_exp_f32_e64 v224, v224
    v_exp_f32 v225, v225
    v_exp_f32 v226, v226
    v_exp_f32 v227, v227
    v_exp_f32 v228, v228
    v_exp_f32 v229, v229
    v_exp_f32 v230, v230
    v_exp_f32 v231, v231
    s_set_gpr_idx_on s66, gpr_idx(SRC1)
    v_pk_fma_f32 v[224:225], v[224:225], v[8:9], s[64:65] clamp
    v_pk_fma_f32 v[226:227], v[226:227], v[10:11], s[64:65] clamp
    v_pk_fma_f32 v[228:229], v[228:229], v[8:9], s[64:65] clamp
    v_pk_fma_f32 v[230:231], v[230:231], v[10:11], s[64:65] clamp
    s_set_gpr_idx_mode gpr_idx()
    s_lshr_b32 s66, s66, 8
    v_pk_mul_f32 v[180:181], v[180:181], v[228:229]
    v_pk_mul_f32 v[182:183], v[182:183], v[230:231]
    v_lshl_add_u64 v[234:235], v[234:235], 0, v[236:237]
    v_pk_fma_f32 v[180:181], v[184:185], v[224:225], v[180:181]
    v_pk_fma_f32 v[182:183], v[186:187], v[226:227], v[182:183]
    v_pk_add_f32 v[184:185], v[224:225], v[228:229]
    v_pk_add_f32 v[186:187], v[226:227], v[230:231]
    v_pk_mul_f32 v[224:225], v[224:225], v[228:229]
    v_pk_mul_f32 v[226:227], v[226:227], v[230:231]
    v_rcp_f32_e64 v224, v224
    v_rcp_f32 v225, v225
    v_rcp_f32 v226, v226
    v_rcp_f32 v227, v227
    s_set_gpr_idx_mode gpr_idx(SRC2,DST)
    v_pk_fma_f32 v[0:1], v[180:181], v[224:225], v[0:1]
    v_pk_fma_f32 v[4:5], v[184:185], v[224:225], v[4:5]
    v_pk_fma_f32 v[2:3], v[182:183], v[226:227], v[2:3]
    v_pk_fma_f32 v[6:7], v[186:187], v[226:227], v[6:7]
    buffer_load_dwordx4 v[180:183], v234, s[28:31], 0 offen sc1
    buffer_load_dwordx4 v[184:187], v235, s[28:31], 0 offen sc1
    s_set_gpr_idx_off
    s_waitcnt vmcnt(6)
    ds_read_b128 v[232:235], v238 offset:96
    v_fma_mix_f32 v224, v112, s63, v188 op_sel_hi:[0,0,1]
    v_fma_mix_f32 v225, v128, s63, v189 op_sel_hi:[0,0,1]
    v_fma_mix_f32 v226, v144, s63, v190 op_sel_hi:[0,0,1]
    v_fma_mix_f32 v227, v160, s63, v191 op_sel_hi:[0,0,1]
    v_fma_mix_f32 v228, v113, s63, v192 op_sel_hi:[0,0,1]
    v_fma_mix_f32 v229, v129, s63, v193 op_sel_hi:[0,0,1]
    v_fma_mix_f32 v230, v145, s63, v194 op_sel_hi:[0,0,1]
    v_fma_mix_f32 v231, v161, s63, v195 op_sel_hi:[0,0,1]
    v_exp_f32 v224, v224
    v_exp_f32 v225, v225
    v_exp_f32 v226, v226
    v_exp_f32 v227, v227
    v_exp_f32 v228, v228
    v_exp_f32 v229, v229
    v_exp_f32 v230, v230
    v_exp_f32 v231, v231
    s_waitcnt lgkmcnt(0)
    s_set_gpr_idx_on s66, gpr_idx(SRC1)
    v_pk_fma_f32 v[224:225], v[224:225], v[8:9], s[64:65] clamp
    v_pk_fma_f32 v[226:227], v[226:227], v[10:11], s[64:65] clamp
    v_pk_fma_f32 v[228:229], v[228:229], v[8:9], s[64:65] clamp
    v_pk_fma_f32 v[230:231], v[230:231], v[10:11], s[64:65] clamp
    s_set_gpr_idx_mode gpr_idx()
    s_lshr_b32 s66, s66, 8
    v_pk_mul_f32 v[188:189], v[188:189], v[228:229]
    v_pk_mul_f32 v[190:191], v[190:191], v[230:231]
    v_lshl_add_u64 v[232:233], v[232:233], 0, v[236:237]
    v_pk_fma_f32 v[188:189], v[192:193], v[224:225], v[188:189]
    v_pk_fma_f32 v[190:191], v[194:195], v[226:227], v[190:191]
    v_pk_add_f32 v[192:193], v[224:225], v[228:229]
    v_pk_add_f32 v[194:195], v[226:227], v[230:231]
    v_pk_mul_f32 v[224:225], v[224:225], v[228:229]
    v_pk_mul_f32 v[226:227], v[226:227], v[230:231]
    v_rcp_f32_e64 v224, v224
    v_rcp_f32 v225, v225
    v_rcp_f32 v226, v226
    v_rcp_f32 v227, v227
    s_set_gpr_idx_mode gpr_idx(SRC2,DST)
    v_pk_fma_f32 v[0:1], v[188:189], v[224:225], v[0:1]
    v_pk_fma_f32 v[4:5], v[192:193], v[224:225], v[4:5]
    v_pk_fma_f32 v[2:3], v[190:191], v[226:227], v[2:3]
    v_pk_fma_f32 v[6:7], v[194:195], v[226:227], v[6:7]
    buffer_load_dwordx4 v[188:191], v232, s[28:31], 0 offen sc1
    buffer_load_dwordx4 v[192:195], v233, s[28:31], 0 offen sc1
    s_set_gpr_idx_off
    s_waitcnt vmcnt(6)
    ds_read_b32 v240, v239 offset:1280
    v_fma_mix_f32 v224, v114, s63, v196 op_sel_hi:[0,0,1]
    v_fma_mix_f32 v225, v130, s63, v197 op_sel_hi:[0,0,1]
    v_fma_mix_f32 v226, v146, s63, v198 op_sel_hi:[0,0,1]
    v_fma_mix_f32 v227, v162, s63, v199 op_sel_hi:[0,0,1]
    v_fma_mix_f32 v228, v115, s63, v200 op_sel_hi:[0,0,1]
    v_fma_mix_f32 v229, v131, s63, v201 op_sel_hi:[0,0,1]
    v_fma_mix_f32 v230, v147, s63, v202 op_sel_hi:[0,0,1]
    v_fma_mix_f32 v231, v163, s63, v203 op_sel_hi:[0,0,1]
    v_exp_f32 v224, v224
    v_exp_f32 v225, v225
    v_exp_f32 v226, v226
    v_exp_f32 v227, v227
    v_exp_f32 v228, v228
    v_exp_f32 v229, v229
    v_exp_f32 v230, v230
    v_exp_f32 v231, v231
    s_waitcnt lgkmcnt(0)
    s_set_gpr_idx_on s66, gpr_idx(SRC1)
    v_pk_fma_f32 v[224:225], v[224:225], v[8:9], s[64:65] clamp
    v_pk_fma_f32 v[226:227], v[226:227], v[10:11], s[64:65] clamp
    v_pk_fma_f32 v[228:229], v[228:229], v[8:9], s[64:65] clamp
    v_pk_fma_f32 v[230:231], v[230:231], v[10:11], s[64:65] clamp
    s_set_gpr_idx_mode gpr_idx()
    s_lshr_b32 s66, s66, 8
    v_add_u32_e64 v240, v240, v241
    buffer_load_dwordx4 v[220:223], v240, s[32:35], 0 offen
    v_pk_mul_f32 v[196:197], v[196:197], v[228:229]
    v_pk_mul_f32 v[198:199], v[198:199], v[230:231]
    v_lshl_add_u64 v[234:235], v[234:235], 0, v[236:237]
    v_pk_fma_f32 v[196:197], v[200:201], v[224:225], v[196:197]
    v_pk_fma_f32 v[198:199], v[202:203], v[226:227], v[198:199]
    v_pk_add_f32 v[200:201], v[224:225], v[228:229]
    v_pk_add_f32 v[202:203], v[226:227], v[230:231]
    v_pk_mul_f32 v[224:225], v[224:225], v[228:229]
    v_pk_mul_f32 v[226:227], v[226:227], v[230:231]
    v_rcp_f32_e64 v224, v224
    v_rcp_f32 v225, v225
    v_rcp_f32 v226, v226
    v_rcp_f32 v227, v227
    s_set_gpr_idx_mode gpr_idx(SRC2,DST)
    v_pk_fma_f32 v[0:1], v[196:197], v[224:225], v[0:1]
    v_pk_fma_f32 v[4:5], v[200:201], v[224:225], v[4:5]
    v_pk_fma_f32 v[2:3], v[198:199], v[226:227], v[2:3]
    v_pk_fma_f32 v[6:7], v[202:203], v[226:227], v[6:7]
    buffer_load_dwordx4 v[196:199], v234, s[28:31], 0 offen sc1
    buffer_load_dwordx4 v[200:203], v235, s[28:31], 0 offen sc1
    s_set_gpr_idx_off
    s_waitcnt vmcnt(7)
    ds_read_b128 v[232:235], v238 offset:128
    v_fma_mix_f32 v224, v116, s63, v172 op_sel_hi:[0,0,1]
    v_fma_mix_f32 v225, v132, s63, v173 op_sel_hi:[0,0,1]
    v_fma_mix_f32 v226, v148, s63, v174 op_sel_hi:[0,0,1]
    v_fma_mix_f32 v227, v164, s63, v175 op_sel_hi:[0,0,1]
    v_fma_mix_f32 v228, v117, s63, v176 op_sel_hi:[0,0,1]
    v_fma_mix_f32 v229, v133, s63, v177 op_sel_hi:[0,0,1]
    v_fma_mix_f32 v230, v149, s63, v178 op_sel_hi:[0,0,1]
    v_fma_mix_f32 v231, v165, s63, v179 op_sel_hi:[0,0,1]
    v_exp_f32 v224, v224
    v_exp_f32 v225, v225
    v_exp_f32 v226, v226
    v_exp_f32 v227, v227
    v_exp_f32 v228, v228
    v_exp_f32 v229, v229
    v_exp_f32 v230, v230
    v_exp_f32 v231, v231
    s_waitcnt lgkmcnt(0)
    s_set_gpr_idx_on s67, gpr_idx(SRC1)
    v_pk_fma_f32 v[224:225], v[224:225], v[8:9], s[64:65] clamp
    v_pk_fma_f32 v[226:227], v[226:227], v[10:11], s[64:65] clamp
    v_pk_fma_f32 v[228:229], v[228:229], v[8:9], s[64:65] clamp
    v_pk_fma_f32 v[230:231], v[230:231], v[10:11], s[64:65] clamp
    s_set_gpr_idx_mode gpr_idx()
    s_lshr_b32 s67, s67, 8
    v_pk_mul_f32 v[172:173], v[172:173], v[228:229]
    v_pk_mul_f32 v[174:175], v[174:175], v[230:231]
    v_lshl_add_u64 v[232:233], v[232:233], 0, v[236:237]
    v_pk_fma_f32 v[172:173], v[176:177], v[224:225], v[172:173]
    v_pk_fma_f32 v[174:175], v[178:179], v[226:227], v[174:175]
    v_pk_add_f32 v[176:177], v[224:225], v[228:229]
    v_pk_add_f32 v[178:179], v[226:227], v[230:231]
    v_pk_mul_f32 v[224:225], v[224:225], v[228:229]
    v_pk_mul_f32 v[226:227], v[226:227], v[230:231]
    v_rcp_f32_e64 v224, v224
    v_rcp_f32 v225, v225
    v_rcp_f32 v226, v226
    v_rcp_f32 v227, v227
    s_set_gpr_idx_mode gpr_idx(SRC2,DST)
    v_pk_fma_f32 v[0:1], v[172:173], v[224:225], v[0:1]
    v_pk_fma_f32 v[4:5], v[176:177], v[224:225], v[4:5]
    v_pk_fma_f32 v[2:3], v[174:175], v[226:227], v[2:3]
    v_pk_fma_f32 v[6:7], v[178:179], v[226:227], v[6:7]
    buffer_load_dwordx4 v[172:175], v232, s[28:31], 0 offen sc1
    buffer_load_dwordx4 v[176:179], v233, s[28:31], 0 offen sc1
    s_set_gpr_idx_off
    s_waitcnt vmcnt(7)
    v_fma_mix_f32 v224, v118, s63, v180 op_sel_hi:[0,0,1]
    v_fma_mix_f32 v225, v134, s63, v181 op_sel_hi:[0,0,1]
    v_fma_mix_f32 v226, v150, s63, v182 op_sel_hi:[0,0,1]
    v_fma_mix_f32 v227, v166, s63, v183 op_sel_hi:[0,0,1]
    v_fma_mix_f32 v228, v119, s63, v184 op_sel_hi:[0,0,1]
    v_fma_mix_f32 v229, v135, s63, v185 op_sel_hi:[0,0,1]
    v_fma_mix_f32 v230, v151, s63, v186 op_sel_hi:[0,0,1]
    v_fma_mix_f32 v231, v167, s63, v187 op_sel_hi:[0,0,1]
    v_exp_f32_e64 v224, v224
    v_exp_f32 v225, v225
    v_exp_f32 v226, v226
    v_exp_f32 v227, v227
    v_exp_f32 v228, v228
    v_exp_f32 v229, v229
    v_exp_f32 v230, v230
    v_exp_f32 v231, v231
    s_set_gpr_idx_on s67, gpr_idx(SRC1)
    v_pk_fma_f32 v[224:225], v[224:225], v[8:9], s[64:65] clamp
    v_pk_fma_f32 v[226:227], v[226:227], v[10:11], s[64:65] clamp
    v_pk_fma_f32 v[228:229], v[228:229], v[8:9], s[64:65] clamp
    v_pk_fma_f32 v[230:231], v[230:231], v[10:11], s[64:65] clamp
    s_set_gpr_idx_mode gpr_idx()
    s_lshr_b32 s67, s67, 8
    v_pk_mul_f32 v[180:181], v[180:181], v[228:229]
    v_pk_mul_f32 v[182:183], v[182:183], v[230:231]
    v_lshl_add_u64 v[234:235], v[234:235], 0, v[236:237]
    v_pk_fma_f32 v[180:181], v[184:185], v[224:225], v[180:181]
    v_pk_fma_f32 v[182:183], v[186:187], v[226:227], v[182:183]
    v_pk_add_f32 v[184:185], v[224:225], v[228:229]
    v_pk_add_f32 v[186:187], v[226:227], v[230:231]
    v_pk_mul_f32 v[224:225], v[224:225], v[228:229]
    v_pk_mul_f32 v[226:227], v[226:227], v[230:231]
    v_rcp_f32_e64 v224, v224
    v_rcp_f32 v225, v225
    v_rcp_f32 v226, v226
    v_rcp_f32 v227, v227
    s_set_gpr_idx_mode gpr_idx(SRC2,DST)
    v_pk_fma_f32 v[0:1], v[180:181], v[224:225], v[0:1]
    v_pk_fma_f32 v[4:5], v[184:185], v[224:225], v[4:5]
    v_pk_fma_f32 v[2:3], v[182:183], v[226:227], v[2:3]
    v_pk_fma_f32 v[6:7], v[186:187], v[226:227], v[6:7]
    buffer_load_dwordx4 v[180:183], v234, s[28:31], 0 offen sc1
    buffer_load_dwordx4 v[184:187], v235, s[28:31], 0 offen sc1
    s_set_gpr_idx_off
    s_waitcnt vmcnt(7)
    ds_read_b128 v[232:235], v238 offset:160
    v_fma_mix_f32 v224, v120, s63, v188 op_sel_hi:[0,0,1]
    v_fma_mix_f32 v225, v136, s63, v189 op_sel_hi:[0,0,1]
    v_fma_mix_f32 v226, v152, s63, v190 op_sel_hi:[0,0,1]
    v_fma_mix_f32 v227, v168, s63, v191 op_sel_hi:[0,0,1]
    v_fma_mix_f32 v228, v121, s63, v192 op_sel_hi:[0,0,1]
    v_fma_mix_f32 v229, v137, s63, v193 op_sel_hi:[0,0,1]
    v_fma_mix_f32 v230, v153, s63, v194 op_sel_hi:[0,0,1]
    v_fma_mix_f32 v231, v169, s63, v195 op_sel_hi:[0,0,1]
    v_exp_f32 v224, v224
    v_exp_f32 v225, v225
    v_exp_f32 v226, v226
    v_exp_f32 v227, v227
    v_exp_f32 v228, v228
    v_exp_f32 v229, v229
    v_exp_f32 v230, v230
    v_exp_f32 v231, v231
    s_waitcnt lgkmcnt(0)
    s_set_gpr_idx_on s67, gpr_idx(SRC1)
    v_pk_fma_f32 v[224:225], v[224:225], v[8:9], s[64:65] clamp
    v_pk_fma_f32 v[226:227], v[226:227], v[10:11], s[64:65] clamp
    v_pk_fma_f32 v[228:229], v[228:229], v[8:9], s[64:65] clamp
    v_pk_fma_f32 v[230:231], v[230:231], v[10:11], s[64:65] clamp
    s_set_gpr_idx_mode gpr_idx()
    s_lshr_b32 s67, s67, 8
    v_pk_mul_f32 v[188:189], v[188:189], v[228:229]
    v_pk_mul_f32 v[190:191], v[190:191], v[230:231]
    v_lshl_add_u64 v[232:233], v[232:233], 0, v[236:237]
    v_pk_fma_f32 v[188:189], v[192:193], v[224:225], v[188:189]
    v_pk_fma_f32 v[190:191], v[194:195], v[226:227], v[190:191]
    v_pk_add_f32 v[192:193], v[224:225], v[228:229]
    v_pk_add_f32 v[194:195], v[226:227], v[230:231]
    v_pk_mul_f32 v[224:225], v[224:225], v[228:229]
    v_pk_mul_f32 v[226:227], v[226:227], v[230:231]
    v_rcp_f32_e64 v224, v224
    v_rcp_f32 v225, v225
    v_rcp_f32 v226, v226
    v_rcp_f32 v227, v227
    s_set_gpr_idx_mode gpr_idx(SRC2,DST)
    v_pk_fma_f32 v[0:1], v[188:189], v[224:225], v[0:1]
    v_pk_fma_f32 v[4:5], v[192:193], v[224:225], v[4:5]
    v_pk_fma_f32 v[2:3], v[190:191], v[226:227], v[2:3]
    v_pk_fma_f32 v[6:7], v[194:195], v[226:227], v[6:7]
    buffer_load_dwordx4 v[188:191], v232, s[28:31], 0 offen sc1
    buffer_load_dwordx4 v[192:195], v233, s[28:31], 0 offen sc1
    s_set_gpr_idx_off
    s_waitcnt vmcnt(6)
    v_fma_mix_f32 v224, v122, s63, v196 op_sel_hi:[0,0,1]
    v_fma_mix_f32 v228, v123, s63, v200 op_sel_hi:[0,0,1]
    v_mfma_f32_32x32x16_bf16 v[108:123], v[220:223], v[204:207], 0
    v_fma_mix_f32 v225, v138, s63, v197 op_sel_hi:[0,0,1]
    v_fma_mix_f32 v229, v139, s63, v201 op_sel_hi:[0,0,1]
    v_exp_f32 v224, v224
    v_exp_f32 v228, v228
    v_mfma_f32_32x32x16_bf16 v[124:139], v[220:223], v[208:211], 0
    v_fma_mix_f32 v226, v154, s63, v198 op_sel_hi:[0,0,1]
    v_fma_mix_f32 v230, v155, s63, v202 op_sel_hi:[0,0,1]
    v_exp_f32 v225, v225
    v_exp_f32 v229, v229
    v_mfma_f32_32x32x16_bf16 v[140:155], v[220:223], v[212:215], 0
    v_fma_mix_f32 v227, v170, s63, v199 op_sel_hi:[0,0,1]
    v_fma_mix_f32 v231, v171, s63, v203 op_sel_hi:[0,0,1]
    v_exp_f32 v226, v226
    v_exp_f32 v230, v230
    v_mfma_f32_32x32x16_bf16 v[156:171], v[220:223], v[216:219], 0
    v_exp_f32_e64 v227, v227
    v_exp_f32 v231, v231
    s_set_gpr_idx_on s67, gpr_idx(SRC1)
    v_pk_fma_f32 v[224:225], v[224:225], v[8:9], s[64:65] clamp
    v_pk_fma_f32 v[226:227], v[226:227], v[10:11], s[64:65] clamp
    v_pk_fma_f32 v[228:229], v[228:229], v[8:9], s[64:65] clamp
    v_pk_fma_f32 v[230:231], v[230:231], v[10:11], s[64:65] clamp
    s_set_gpr_idx_mode gpr_idx()
    s_lshr_b32 s67, s67, 8
    v_pk_mul_f32 v[196:197], v[196:197], v[228:229]
    v_pk_mul_f32 v[198:199], v[198:199], v[230:231]
    v_lshl_add_u64 v[234:235], v[234:235], 0, v[236:237]
    v_pk_fma_f32 v[196:197], v[200:201], v[224:225], v[196:197]
    v_pk_fma_f32 v[198:199], v[202:203], v[226:227], v[198:199]
    v_pk_add_f32 v[200:201], v[224:225], v[228:229]
    v_pk_add_f32 v[202:203], v[226:227], v[230:231]
    v_pk_mul_f32 v[224:225], v[224:225], v[228:229]
    v_pk_mul_f32 v[226:227], v[226:227], v[230:231]
    v_rcp_f32_e64 v224, v224
    v_rcp_f32 v225, v225
    v_rcp_f32 v226, v226
    v_rcp_f32 v227, v227
    s_set_gpr_idx_mode gpr_idx(SRC2,DST)
    v_pk_fma_f32 v[0:1], v[196:197], v[224:225], v[0:1]
    v_pk_fma_f32 v[4:5], v[200:201], v[224:225], v[4:5]
    v_pk_fma_f32 v[2:3], v[198:199], v[226:227], v[2:3]
    v_pk_fma_f32 v[6:7], v[202:203], v[226:227], v[6:7]
    buffer_load_dwordx4 v[196:199], v234, s[28:31], 0 offen sc1
    buffer_load_dwordx4 v[200:203], v235, s[28:31], 0 offen sc1
    s_set_gpr_idx_off
    s_nop 0
    v_readlane_b32 s66, v242, s68
    v_readlane_b32 s67, v242, s69
    v_add_u32 v238, 0x80, v238
    v_add_u32 v239, 0x80, v239
    s_add_u32 s68, s68, 2
    s_add_u32 s69, s69, 2
    s_cmp_le_i32 s60, s94
    s_cbranch_scc0 Lprio_done
    s_setprio 2
    s_cmp_le_i32 s60, s95
    s_cbranch_scc0 Lprio_done
    s_setprio 1
    s_cmp_le_i32 s60, s96
    s_cbranch_scc0 Lprio_done
    s_setprio 0
Lprio_done:
    s_cmp_gt_u32 s60, 8
    s_cbranch_scc1 Ltile
    .p2align 3
Llast:
    ds_read_b32 v247, v253
    s_waitcnt lgkmcnt(0)
    v_cmp_gt_u32 vcc, 4, v247
    s_cbranch_vccnz Llast
    s_waitcnt vmcnt(6)
    ds_read_b128 v[232:235], v238 offset:64
    v_fma_mix_f32 v224, v108, s63, v172 op_sel_hi:[0,0,1]
    v_fma_mix_f32 v225, v124, s63, v173 op_sel_hi:[0,0,1]
    v_fma_mix_f32 v226, v140, s63, v174 op_sel_hi:[0,0,1]
    v_fma_mix_f32 v227, v156, s63, v175 op_sel_hi:[0,0,1]
    v_fma_mix_f32 v228, v109, s63, v176 op_sel_hi:[0,0,1]
    v_fma_mix_f32 v229, v125, s63, v177 op_sel_hi:[0,0,1]
    v_fma_mix_f32 v230, v141, s63, v178 op_sel_hi:[0,0,1]
    v_fma_mix_f32 v231, v157, s63, v179 op_sel_hi:[0,0,1]
    v_exp_f32 v224, v224
    v_exp_f32 v225, v225
    v_exp_f32 v226, v226
    v_exp_f32 v227, v227
    v_exp_f32 v228, v228
    v_exp_f32 v229, v229
    v_exp_f32 v230, v230
    v_exp_f32 v231, v231
    s_waitcnt lgkmcnt(0)
    s_set_gpr_idx_on s66, gpr_idx(SRC1)
    v_pk_fma_f32 v[224:225], v[224:225], v[8:9], s[64:65] clamp
    v_pk_fma_f32 v[226:227], v[226:227], v[10:11], s[64:65] clamp
    v_pk_fma_f32 v[228:229], v[228:229], v[8:9], s[64:65] clamp
    v_pk_fma_f32 v[230:231], v[230:231], v[10:11], s[64:65] clamp
    s_set_gpr_idx_mode gpr_idx()
    s_lshr_b32 s66, s66, 8
    v_pk_mul_f32 v[172:173], v[172:173], v[228:229]
    v_pk_mul_f32 v[174:175], v[174:175], v[230:231]
    v_lshl_add_u64 v[232:233], v[232:233], 0, v[236:237]
    v_pk_fma_f32 v[172:173], v[176:177], v[224:225], v[172:173]
    v_pk_fma_f32 v[174:175], v[178:179], v[226:227], v[174:175]
    v_pk_add_f32 v[176:177], v[224:225], v[228:229]
    v_pk_add_f32 v[178:179], v[226:227], v[230:231]
    v_pk_mul_f32 v[224:225], v[224:225], v[228:229]
    v_pk_mul_f32 v[226:227], v[226:227], v[230:231]
    v_rcp_f32_e64 v224, v224
    v_rcp_f32 v225, v225
    v_rcp_f32 v226, v226
    v_rcp_f32 v227, v227
    s_set_gpr_idx_mode gpr_idx(SRC2,DST)
    v_pk_fma_f32 v[0:1], v[172:173], v[224:225], v[0:1]
    v_pk_fma_f32 v[4:5], v[176:177], v[224:225], v[4:5]
    v_pk_fma_f32 v[2:3], v[174:175], v[226:227], v[2:3]
    v_pk_fma_f32 v[6:7], v[178:179], v[226:227], v[6:7]
    buffer_load_dwordx4 v[172:175], v232, s[28:31], 0 offen sc1
    buffer_load_dwordx4 v[176:179], v233, s[28:31], 0 offen sc1
    s_set_gpr_idx_off
    s_cmp_le_u32 s60, 1
    s_cbranch_scc1 Lmain_done
    s_waitcnt vmcnt(6)
    v_fma_mix_f32 v224, v110, s63, v180 op_sel_hi:[0,0,1]
    v_fma_mix_f32 v225, v126, s63, v181 op_sel_hi:[0,0,1]
    v_fma_mix_f32 v226, v142, s63, v182 op_sel_hi:[0,0,1]
    v_fma_mix_f32 v227, v158, s63, v183 op_sel_hi:[0,0,1]
    v_fma_mix_f32 v228, v111, s63, v184 op_sel_hi:[0,0,1]
    v_fma_mix_f32 v229, v127, s63, v185 op_sel_hi:[0,0,1]
    v_fma_mix_f32 v230, v143, s63, v186 op_sel_hi:[0,0,1]
    v_fma_mix_f32 v231, v159, s63, v187 op_sel_hi:[0,0,1]
    v_exp_f32_e64 v224, v224
    v_exp_f32 v225, v225
    v_exp_f32 v226, v226
    v_exp_f32 v227, v227
    v_exp_f32 v228, v228
    v_exp_f32 v229, v229
    v_exp_f32 v230, v230
    v_exp_f32 v231, v231
    s_set_gpr_idx_on s66, gpr_idx(SRC1)
    v_pk_fma_f32 v[224:225], v[224:225], v[8:9], s[64:65] clamp
    v_pk_fma_f32 v[226:227], v[226:227], v[10:11], s[64:65] clamp
    v_pk_fma_f32 v[228:229], v[228:229], v[8:9], s[64:65] clamp
    v_pk_fma_f32 v[230:231], v[230:231], v[10:11], s[64:65] clamp
    s_set_gpr_idx_mode gpr_idx()
    s_lshr_b32 s66, s66, 8
    v_pk_mul_f32 v[180:181], v[180:181], v[228:229]
    v_pk_mul_f32 v[182:183], v[182:183], v[230:231]
    v_lshl_add_u64 v[234:235], v[234:235], 0, v[236:237]
    v_pk_fma_f32 v[180:181], v[184:185], v[224:225], v[180:181]
    v_pk_fma_f32 v[182:183], v[186:187], v[226:227], v[182:183]
    v_pk_add_f32 v[184:185], v[224:225], v[228:229]
    v_pk_add_f32 v[186:187], v[226:227], v[230:231]
    v_pk_mul_f32 v[224:225], v[224:225], v[228:229]
    v_pk_mul_f32 v[226:227], v[226:227], v[230:231]
    v_rcp_f32_e64 v224, v224
    v_rcp_f32 v225, v225
    v_rcp_f32 v226, v226
    v_rcp_f32 v227, v227
    s_set_gpr_idx_mode gpr_idx(SRC2,DST)
    v_pk_fma_f32 v[0:1], v[180:181], v[224:225], v[0:1]
    v_pk_fma_f32 v[4:5], v[184:185], v[224:225], v[4:5]
    v_pk_fma_f32 v[2:3], v[182:183], v[226:227], v[2:3]
    v_pk_fma_f32 v[6:7], v[186:187], v[226:227], v[6:7]
    buffer_load_dwordx4 v[180:183], v234, s[28:31], 0 offen sc1
    buffer_load_dwordx4 v[184:187], v235, s[28:31], 0 offen sc1
    s_set_gpr_idx_off
    s_cmp_le_u32 s60, 2
    s_cbranch_scc1 Lmain_done
    s_waitcnt vmcnt(6)
    ds_read_b128 v[232:235], v238 offset:96
    v_fma_mix_f32 v224, v112, s63, v188 op_sel_hi:[0,0,1]
    v_fma_mix_f32 v225, v128, s63, v189 op_sel_hi:[0,0,1]
    v_fma_mix_f32 v226, v144, s63, v190 op_sel_hi:[0,0,1]
    v_fma_mix_f32 v227, v160, s63, v191 op_sel_hi:[0,0,1]
    v_fma_mix_f32 v228, v113, s63, v192 op_sel_hi:[0,0,1]
    v_fma_mix_f32 v229, v129, s63, v193 op_sel_hi:[0,0,1]
    v_fma_mix_f32 v230, v145, s63, v194 op_sel_hi:[0,0,1]
    v_fma_mix_f32 v231, v161, s63, v195 op_sel_hi:[0,0,1]
    v_exp_f32 v224, v224
    v_exp_f32 v225, v225
    v_exp_f32 v226, v226
    v_exp_f32 v227, v227
    v_exp_f32 v228, v228
    v_exp_f32 v229, v229
    v_exp_f32 v230, v230
    v_exp_f32 v231, v231
    s_waitcnt lgkmcnt(0)
    s_set_gpr_idx_on s66, gpr_idx(SRC1)
    v_pk_fma_f32 v[224:225], v[224:225], v[8:9], s[64:65] clamp
    v_pk_fma_f32 v[226:227], v[226:227], v[10:11], s[64:65] clamp
    v_pk_fma_f32 v[228:229], v[228:229], v[8:9], s[64:65] clamp
    v_pk_fma_f32 v[230:231], v[230:231], v[10:11], s[64:65] clamp
    s_set_gpr_idx_mode gpr_idx()
    s_lshr_b32 s66, s66, 8
    v_pk_mul_f32 v[188:189], v[188:189], v[228:229]
    v_pk_mul_f32 v[190:191], v[190:191], v[230:231]
    v_lshl_add_u64 v[232:233], v[232:233], 0, v[236:237]
    v_pk_fma_f32 v[188:189], v[192:193], v[224:225], v[188:189]
    v_pk_fma_f32 v[190:191], v[194:195], v[226:227], v[190:191]
    v_pk_add_f32 v[192:193], v[224:225], v[228:229]
    v_pk_add_f32 v[194:195], v[226:227], v[230:231]
    v_pk_mul_f32 v[224:225], v[224:225], v[228:229]
    v_pk_mul_f32 v[226:227], v[226:227], v[230:231]
    v_rcp_f32_e64 v224, v224
    v_rcp_f32 v225, v225
    v_rcp_f32 v226, v226
    v_rcp_f32 v227, v227
    s_set_gpr_idx_mode gpr_idx(SRC2,DST)
    v_pk_fma_f32 v[0:1], v[188:189], v[224:225], v[0:1]
    v_pk_fma_f32 v[4:5], v[192:193], v[224:225], v[4:5]
    v_pk_fma_f32 v[2:3], v[190:191], v[226:227], v[2:3]
    v_pk_fma_f32 v[6:7], v[194:195], v[226:227], v[6:7]
    buffer_load_dwordx4 v[188:191], v232, s[28:31], 0 offen sc1
    buffer_load_dwordx4 v[192:195], v233, s[28:31], 0 offen sc1
    s_set_gpr_idx_off
    s_cmp_le_u32 s60, 3
    s_cbranch_scc1 Lmain_done
    s_waitcnt vmcnt(6)
    v_fma_mix_f32 v224, v114, s63, v196 op_sel_hi:[0,0,1]
    v_fma_mix_f32 v225, v130, s63, v197 op_sel_hi:[0,0,1]
    v_fma_mix_f32 v226, v146, s63, v198 op_sel_hi:[0,0,1]
    v_fma_mix_f32 v227, v162, s63, v199 op_sel_hi:[0,0,1]
    v_fma_mix_f32 v228, v115, s63, v200 op_sel_hi:[0,0,1]
    v_fma_mix_f32 v229, v131, s63, v201 op_sel_hi:[0,0,1]
    v_fma_mix_f32 v230, v147, s63, v202 op_sel_hi:[0,0,1]
    v_fma_mix_f32 v231, v163, s63, v203 op_sel_hi:[0,0,1]
    v_exp_f32_e64 v224, v224
    v_exp_f32 v225, v225
    v_exp_f32 v226, v226
    v_exp_f32 v227, v227
    v_exp_f32 v228, v228
    v_exp_f32 v229, v229
    v_exp_f32 v230, v230
    v_exp_f32 v231, v231
    s_set_gpr_idx_on s66, gpr_idx(SRC1)
    v_pk_fma_f32 v[224:225], v[224:225], v[8:9], s[64:65] clamp
    v_pk_fma_f32 v[226:227], v[226:227], v[10:11], s[64:65] clamp
    v_pk_fma_f32 v[228:229], v[228:229], v[8:9], s[64:65] clamp
    v_pk_fma_f32 v[230:231], v[230:231], v[10:11], s[64:65] clamp
    s_set_gpr_idx_mode gpr_idx()
    s_lshr_b32 s66, s66, 8
    v_pk_mul_f32 v[196:197], v[196:197], v[228:229]
    v_pk_mul_f32 v[198:199], v[198:199], v[230:231]
    v_lshl_add_u64 v[234:235], v[234:235], 0, v[236:237]
    v_pk_fma_f32 v[196:197], v[200:201], v[224:225], v[196:197]
    v_pk_fma_f32 v[198:199], v[202:203], v[226:227], v[198:199]
    v_pk_add_f32 v[200:201], v[224:225], v[228:229]
    v_pk_add_f32 v[202:203], v[226:227], v[230:231]
    v_pk_mul_f32 v[224:225], v[224:225], v[228:229]
    v_pk_mul_f32 v[226:227], v[226:227], v[230:231]
    v_rcp_f32_e64 v224, v224
    v_rcp_f32 v225, v225
    v_rcp_f32 v226, v226
    v_rcp_f32 v227, v227
    s_set_gpr_idx_mode gpr_idx(SRC2,DST)
    v_pk_fma_f32 v[0:1], v[196:197], v[224:225], v[0:1]
    v_pk_fma_f32 v[4:5], v[200:201], v[224:225], v[4:5]
    v_pk_fma_f32 v[2:3], v[198:199], v[226:227], v[2:3]
    v_pk_fma_f32 v[6:7], v[202:203], v[226:227], v[6:7]
    buffer_load_dwordx4 v[196:199], v234, s[28:31], 0 offen sc1
    buffer_load_dwordx4 v[200:203], v235, s[28:31], 0 offen sc1
    s_set_gpr_idx_off
    s_cmp_le_u32 s60, 4
    s_cbranch_scc1 Lmain_done
    s_waitcnt vmcnt(6)
    v_fma_mix_f32 v224, v116, s63, v172 op_sel_hi:[0,0,1]
    v_fma_mix_f32 v225, v132, s63, v173 op_sel_hi:[0,0,1]
    v_fma_mix_f32 v226, v148, s63, v174 op_sel_hi:[0,0,1]
    v_fma_mix_f32 v227, v164, s63, v175 op_sel_hi:[0,0,1]
    v_fma_mix_f32 v228, v117, s63, v176 op_sel_hi:[0,0,1]
    v_fma_mix_f32 v229, v133, s63, v177 op_sel_hi:[0,0,1]
    v_fma_mix_f32 v230, v149, s63, v178 op_sel_hi:[0,0,1]
    v_fma_mix_f32 v231, v165, s63, v179 op_sel_hi:[0,0,1]
    v_exp_f32_e64 v224, v224
    v_exp_f32 v225, v225
    v_exp_f32 v226, v226
    v_exp_f32 v227, v227
    v_exp_f32 v228, v228
    v_exp_f32 v229, v229
    v_exp_f32 v230, v230
    v_exp_f32 v231, v231
    s_set_gpr_idx_on s67, gpr_idx(SRC1)
    v_pk_fma_f32 v[224:225], v[224:225], v[8:9], s[64:65] clamp
    v_pk_fma_f32 v[226:227], v[226:227], v[10:11], s[64:65] clamp
    v_pk_fma_f32 v[228:229], v[228:229], v[8:9], s[64:65] clamp
    v_pk_fma_f32 v[230:231], v[230:231], v[10:11], s[64:65] clamp
    s_set_gpr_idx_mode gpr_idx()
    s_lshr_b32 s67, s67, 8
    v_pk_mul_f32 v[172:173], v[172:173], v[228:229]
    v_pk_mul_f32 v[174:175], v[174:175], v[230:231]
    v_pk_fma_f32 v[172:173], v[176:177], v[224:225], v[172:173]
    v_pk_fma_f32 v[174:175], v[178:179], v[226:227], v[174:175]
    v_pk_add_f32 v[176:177], v[224:225], v[228:229]
    v_pk_add_f32 v[178:179], v[226:227], v[230:231]
    v_pk_mul_f32 v[224:225], v[224:225], v[228:229]
    v_pk_mul_f32 v[226:227], v[226:227], v[230:231]
    v_rcp_f32_e64 v224, v224
    v_rcp_f32 v225, v225
    v_rcp_f32 v226, v226
    v_rcp_f32 v227, v227
    s_set_gpr_idx_mode gpr_idx(SRC2,DST)
    v_pk_fma_f32 v[0:1], v[172:173], v[224:225], v[0:1]
    v_pk_fma_f32 v[4:5], v[176:177], v[224:225], v[4:5]
    v_pk_fma_f32 v[2:3], v[174:175], v[226:227], v[2:3]
    v_pk_fma_f32 v[6:7], v[178:179], v[226:227], v[6:7]
    s_set_gpr_idx_off
    s_cmp_le_u32 s60, 5
    s_cbranch_scc1 Lmain_done
    s_waitcnt vmcnt(4)
    v_fma_mix_f32 v224, v118, s63, v180 op_sel_hi:[0,0,1]
    v_fma_mix_f32 v225, v134, s63, v181 op_sel_hi:[0,0,1]
    v_fma_mix_f32 v226, v150, s63, v182 op_sel_hi:[0,0,1]
    v_fma_mix_f32 v227, v166, s63, v183 op_sel_hi:[0,0,1]
    v_fma_mix_f32 v228, v119, s63, v184 op_sel_hi:[0,0,1]
    v_fma_mix_f32 v229, v135, s63, v185 op_sel_hi:[0,0,1]
    v_fma_mix_f32 v230, v151, s63, v186 op_sel_hi:[0,0,1]
    v_fma_mix_f32 v231, v167, s63, v187 op_sel_hi:[0,0,1]
    v_exp_f32_e64 v224, v224
    v_exp_f32 v225, v225
    v_exp_f32 v226, v226
    v_exp_f32 v227, v227
    v_exp_f32 v228, v228
    v_exp_f32 v229, v229
    v_exp_f32 v230, v230
    v_exp_f32 v231, v231
    s_set_gpr_idx_on s67, gpr_idx(SRC1)
    v_pk_fma_f32 v[224:225], v[224:225], v[8:9], s[64:65] clamp
    v_pk_fma_f32 v[226:227], v[226:227], v[10:11], s[64:65] clamp
    v_pk_fma_f32 v[228:229], v[228:229], v[8:9], s[64:65] clamp
    v_pk_fma_f32 v[230:231], v[230:231], v[10:11], s[64:65] clamp
    s_set_gpr_idx_mode gpr_idx()
    s_lshr_b32 s67, s67, 8
    v_pk_mul_f32 v[180:181], v[180:181], v[228:229]
    v_pk_mul_f32 v[182:183], v[182:183], v[230:231]
    v_pk_fma_f32 v[180:181], v[184:185], v[224:225], v[180:181]
    v_pk_fma_f32 v[182:183], v[186:187], v[226:227], v[182:183]
    v_pk_add_f32 v[184:185], v[224:225], v[228:229]
    v_pk_add_f32 v[186:187], v[226:227], v[230:231]
    v_pk_mul_f32 v[224:225], v[224:225], v[228:229]
    v_pk_mul_f32 v[226:227], v[226:227], v[230:231]
    v_rcp_f32_e64 v224, v224
    v_rcp_f32 v225, v225
    v_rcp_f32 v226, v226
    v_rcp_f32 v227, v227
    s_set_gpr_idx_mode gpr_idx(SRC2,DST)
    v_pk_fma_f32 v[0:1], v[180:181], v[224:225], v[0:1]
    v_pk_fma_f32 v[4:5], v[184:185], v[224:225], v[4:5]
    v_pk_fma_f32 v[2:3], v[182:183], v[226:227], v[2:3]
    v_pk_fma_f32 v[6:7], v[186:187], v[226:227], v[6:7]
    s_set_gpr_idx_off
    s_cmp_le_u32 s60, 6
    s_cbranch_scc1 Lmain_done
    s_waitcnt vmcnt(2)
    v_fma_mix_f32 v224, v120, s63, v188 op_sel_hi:[0,0,1]
    v_fma_mix_f32 v225, v136, s63, v189 op_sel_hi:[0,0,1]
    v_fma_mix_f32 v226, v152, s63, v190 op_sel_hi:[0,0,1]
    v_fma_mix_f32 v227, v168, s63, v191 op_sel_hi:[0,0,1]
    v_fma_mix_f32 v228, v121, s63, v192 op_sel_hi:[0,0,1]
    v_fma_mix_f32 v229, v137, s63, v193 op_sel_hi:[0,0,1]
    v_fma_mix_f32 v230, v153, s63, v194 op_sel_hi:[0,0,1]
    v_fma_mix_f32 v231, v169, s63, v195 op_sel_hi:[0,0,1]
    v_exp_f32_e64 v224, v224
    v_exp_f32 v225, v225
    v_exp_f32 v226, v226
    v_exp_f32 v227, v227
    v_exp_f32 v228, v228
    v_exp_f32 v229, v229
    v_exp_f32 v230, v230
    v_exp_f32 v231, v231
    s_set_gpr_idx_on s67, gpr_idx(SRC1)
    v_pk_fma_f32 v[224:225], v[224:225], v[8:9], s[64:65] clamp
    v_pk_fma_f32 v[226:227], v[226:227], v[10:11], s[64:65] clamp
    v_pk_fma_f32 v[228:229], v[228:229], v[8:9], s[64:65] clamp
    v_pk_fma_f32 v[230:231], v[230:231], v[10:11], s[64:65] clamp
    s_set_gpr_idx_mode gpr_idx()
    s_lshr_b32 s67, s67, 8
    v_pk_mul_f32 v[188:189], v[188:189], v[228:229]
    v_pk_mul_f32 v[190:191], v[190:191], v[230:231]
    v_pk_fma_f32 v[188:189], v[192:193], v[224:225], v[188:189]
    v_pk_fma_f32 v[190:191], v[194:195], v[226:227], v[190:191]
    v_pk_add_f32 v[192:193], v[224:225], v[228:229]
    v_pk_add_f32 v[194:195], v[226:227], v[230:231]
    v_pk_mul_f32 v[224:225], v[224:225], v[228:229]
    v_pk_mul_f32 v[226:227], v[226:227], v[230:231]
    v_rcp_f32_e64 v224, v224
    v_rcp_f32 v225, v225
    v_rcp_f32 v226, v226
    v_rcp_f32 v227, v227
    s_set_gpr_idx_mode gpr_idx(SRC2,DST)
    v_pk_fma_f32 v[0:1], v[188:189], v[224:225], v[0:1]
    v_pk_fma_f32 v[4:5], v[192:193], v[224:225], v[4:5]
    v_pk_fma_f32 v[2:3], v[190:191], v[226:227], v[2:3]
    v_pk_fma_f32 v[6:7], v[194:195], v[226:227], v[6:7]
    s_set_gpr_idx_off
    s_cmp_le_u32 s60, 7
    s_cbranch_scc1 Lmain_done
    s_waitcnt vmcnt(0)
    v_fma_mix_f32 v224, v122, s63, v196 op_sel_hi:[0,0,1]
    v_fma_mix_f32 v225, v138, s63, v197 op_sel_hi:[0,0,1]
    v_fma_mix_f32 v226, v154, s63, v198 op_sel_hi:[0,0,1]
    v_fma_mix_f32 v227, v170, s63, v199 op_sel_hi:[0,0,1]
    v_fma_mix_f32 v228, v123, s63, v200 op_sel_hi:[0,0,1]
    v_fma_mix_f32 v229, v139, s63, v201 op_sel_hi:[0,0,1]
    v_fma_mix_f32 v230, v155, s63, v202 op_sel_hi:[0,0,1]
    v_fma_mix_f32 v231, v171, s63, v203 op_sel_hi:[0,0,1]
    v_exp_f32_e64 v224, v224
    v_exp_f32 v225, v225
    v_exp_f32 v226, v226
    v_exp_f32 v227, v227
    v_exp_f32 v228, v228
    v_exp_f32 v229, v229
    v_exp_f32 v230, v230
    v_exp_f32 v231, v231
    s_set_gpr_idx_on s67, gpr_idx(SRC1)
    v_pk_fma_f32 v[224:225], v[224:225], v[8:9], s[64:65] clamp
    v_pk_fma_f32 v[226:227], v[226:227], v[10:11], s[64:65] clamp
    v_pk_fma_f32 v[228:229], v[228:229], v[8:9], s[64:65] clamp
    v_pk_fma_f32 v[230:231], v[230:231], v[10:11], s[64:65] clamp
    s_set_gpr_idx_mode gpr_idx()
    s_lshr_b32 s67, s67, 8
    v_pk_mul_f32 v[196:197], v[196:197], v[228:229]
    v_pk_mul_f32 v[198:199], v[198:199], v[230:231]
    v_pk_fma_f32 v[196:197], v[200:201], v[224:225], v[196:197]
    v_pk_fma_f32 v[198:199], v[202:203], v[226:227], v[198:199]
    v_pk_add_f32 v[200:201], v[224:225], v[228:229]
    v_pk_add_f32 v[202:203], v[226:227], v[230:231]
    v_pk_mul_f32 v[224:225], v[224:225], v[228:229]
    v_pk_mul_f32 v[226:227], v[226:227], v[230:231]
    v_rcp_f32_e64 v224, v224
    v_rcp_f32 v225, v225
    v_rcp_f32 v226, v226
    v_rcp_f32 v227, v227
    s_set_gpr_idx_mode gpr_idx(SRC2,DST)
    v_pk_fma_f32 v[0:1], v[196:197], v[224:225], v[0:1]
    v_pk_fma_f32 v[4:5], v[200:201], v[224:225], v[4:5]
    v_pk_fma_f32 v[2:3], v[198:199], v[226:227], v[2:3]
    v_pk_fma_f32 v[6:7], v[202:203], v[226:227], v[6:7]
    s_set_gpr_idx_off
Lmain_done:
    ds_write_b128 v248, v[0:3]
    ds_write_b128 v248, v[4:7] offset:1024
    ds_write_b32 v252, v253 offset:4160
    ds_read_b128 v[108:111], v249 offset:0
    ds_read_b64 v[124:125], v250 offset:0
    ds_read_b128 v[112:115], v249 offset:1056
    ds_read_b64 v[126:127], v250 offset:544
    ds_read_b128 v[116:119], v249 offset:2112
    ds_read_b64 v[128:129], v250 offset:1088
    ds_read_b128 v[120:123], v249 offset:3168
    ds_read_b64 v[130:131], v250 offset:1632
    ds_read_b32 v247, v252 offset:4164
    ds_read_b128 v[140:143], v248 offset:2560
    ds_read_b128 v[144:147], v248 offset:3584
    s_cmp_gt_u32 s99, 2
    s_cbranch_scc1 Lfin0
    s_cmp_eq_u32 s56, 7
    s_cbranch_scc1 Lfin0
Lcarry0:
    s_waitcnt lgkmcnt(0)
    v_cmp_eq_u32 vcc, 0, v247
    s_cbranch_vccz Lcarried0
    s_sleep 1
    ds_read_b32 v247, v252 offset:4164
    ds_read_b128 v[140:143], v248 offset:2560
    ds_read_b128 v[144:147], v248 offset:3584
    s_branch Lcarry0
Lcarried0:
    s_set_gpr_idx_on s93, gpr_idx(SRC0,DST)
    v_pk_add_f32 v[0:1], v[0:1], v[140:141]
    v_pk_add_f32 v[2:3], v[2:3], v[142:143]
    v_pk_add_f32 v[4:5], v[4:5], v[144:145]
    v_pk_add_f32 v[6:7], v[6:7], v[146:147]
    s_set_gpr_idx_off
    s_nop 1
Lfin0:
    v_permlane32_swap_b32 v12, v24
    v_permlane32_swap_b32 v16, v28
    v_permlane32_swap_b32 v13, v25
    v_permlane32_swap_b32 v17, v29
    v_permlane32_swap_b32 v14, v26
    v_permlane32_swap_b32 v18, v30
    v_permlane32_swap_b32 v15, v27
    v_permlane32_swap_b32 v19, v31
    v_pk_add_f32 v[16:17], v[16:17], v[28:29]
    v_pk_add_f32 v[18:19], v[18:19], v[30:31]
    v_pk_add_f32 v[12:13], v[12:13], v[24:25]
    v_pk_add_f32 v[14:15], v[14:15], v[26:27]
    v_rcp_f32 v16, v16
    v_rcp_f32 v17, v17
    v_rcp_f32 v18, v18
    v_rcp_f32 v19, v19
    s_waitcnt lgkmcnt(0)
    v_pk_fma_f32 v[12:13], v[12:13], v[16:17], v[108:109]
    v_pk_fma_f32 v[14:15], v[14:15], v[18:19], v[110:111]
    v_cvt_pk_bf16_f32 v12, v12, v13
    v_cvt_pk_bf16_f32 v13, v14, v15
    v_pk_max_f16 v12, v12, v124
    v_pk_max_f16 v13, v13, v125
    s_cmp_gt_u32 s99, 1
    s_cselect_b32 exec_hi, -1, 0
    buffer_store_dwordx2 v[12:13], v251, s[52:55], s92 offen sc1 nt
    s_add_u32 s92, s92, 512
    s_cmp_gt_u32 s99, 2
    s_cbranch_scc0 Lk2_done
    s_cmp_gt_u32 s99, 4
    s_cbranch_scc1 Lfin1
    s_cmp_eq_u32 s56, 7
    s_cbranch_scc1 Lfin1
Lcarry1:
    s_waitcnt lgkmcnt(0)
    v_cmp_eq_u32 vcc, 0, v247
    s_cbranch_vccz Lcarried1
    s_sleep 1
    ds_read_b32 v247, v252 offset:4164
    ds_read_b128 v[140:143], v248 offset:2560
    ds_read_b128 v[144:147], v248 offset:3584
    s_branch Lcarry1
Lcarried1:
    s_set_gpr_idx_on s93, gpr_idx(SRC0,DST)
    v_pk_add_f32 v[0:1], v[0:1], v[140:141]
    v_pk_add_f32 v[2:3], v[2:3], v[142:143]
    v_pk_add_f32 v[4:5], v[4:5], v[144:145]
    v_pk_add_f32 v[6:7], v[6:7], v[146:147]
    s_set_gpr_idx_off
    s_nop 1
Lfin1:
    v_permlane32_swap_b32 v36, v48
    v_permlane32_swap_b32 v40, v52
    v_permlane32_swap_b32 v37, v49
    v_permlane32_swap_b32 v41, v53
    v_permlane32_swap_b32 v38, v50
    v_permlane32_swap_b32 v42, v54
    v_permlane32_swap_b32 v39, v51
    v_permlane32_swap_b32 v43, v55
    v_pk_add_f32 v[40:41], v[40:41], v[52:53]
    v_pk_add_f32 v[42:43], v[42:43], v[54:55]
    v_pk_add_f32 v[36:37], v[36:37], v[48:49]
    v_pk_add_f32 v[38:39], v[38:39], v[50:51]
    v_rcp_f32 v40, v40
    v_rcp_f32 v41, v41
    v_rcp_f32 v42, v42
    v_rcp_f32 v43, v43
    v_pk_fma_f32 v[36:37], v[36:37], v[40:41], v[112:113]
    v_pk_fma_f32 v[38:39], v[38:39], v[42:43], v[114:115]
    v_cvt_pk_bf16_f32 v36, v36, v37
    v_cvt_pk_bf16_f32 v37, v38, v39
    v_pk_max_f16 v36, v36, v126
    v_pk_max_f16 v37, v37, v127
    s_cmp_gt_u32 s99, 3
    s_cselect_b32 exec_hi, -1, 0
    buffer_store_dwordx2 v[36:37], v251, s[52:55], s92 offen sc1 nt
    s_add_u32 s92, s92, 512
    s_cmp_gt_u32 s99, 4
    s_cbranch_scc0 Lk2_done
    s_cmp_gt_u32 s99, 6
    s_cbranch_scc1 Lfin2
    s_cmp_eq_u32 s56, 7
    s_cbranch_scc1 Lfin2
Lcarry2:
    s_waitcnt lgkmcnt(0)
    v_cmp_eq_u32 vcc, 0, v247
    s_cbranch_vccz Lcarried2
    s_sleep 1
    ds_read_b32 v247, v252 offset:4164
    ds_read_b128 v[140:143], v248 offset:2560
    ds_read_b128 v[144:147], v248 offset:3584
    s_branch Lcarry2
Lcarried2:
    s_set_gpr_idx_on s93, gpr_idx(SRC0,DST)
    v_pk_add_f32 v[0:1], v[0:1], v[140:141]
    v_pk_add_f32 v[2:3], v[2:3], v[142:143]
    v_pk_add_f32 v[4:5], v[4:5], v[144:145]
    v_pk_add_f32 v[6:7], v[6:7], v[146:147]
    s_set_gpr_idx_off
    s_nop 1
Lfin2:
    v_permlane32_swap_b32 v60, v72
    v_permlane32_swap_b32 v64, v76
    v_permlane32_swap_b32 v61, v73
    v_permlane32_swap_b32 v65, v77
    v_permlane32_swap_b32 v62, v74
    v_permlane32_swap_b32 v66, v78
    v_permlane32_swap_b32 v63, v75
    v_permlane32_swap_b32 v67, v79
    v_pk_add_f32 v[64:65], v[64:65], v[76:77]
    v_pk_add_f32 v[66:67], v[66:67], v[78:79]
    v_pk_add_f32 v[60:61], v[60:61], v[72:73]
    v_pk_add_f32 v[62:63], v[62:63], v[74:75]
    v_rcp_f32 v64, v64
    v_rcp_f32 v65, v65
    v_rcp_f32 v66, v66
    v_rcp_f32 v67, v67
    v_pk_fma_f32 v[60:61], v[60:61], v[64:65], v[116:117]
    v_pk_fma_f32 v[62:63], v[62:63], v[66:67], v[118:119]
    v_cvt_pk_bf16_f32 v60, v60, v61
    v_cvt_pk_bf16_f32 v61, v62, v63
    v_pk_max_f16 v60, v60, v128
    v_pk_max_f16 v61, v61, v129
    s_cmp_gt_u32 s99, 5
    s_cselect_b32 exec_hi, -1, 0
    buffer_store_dwordx2 v[60:61], v251, s[52:55], s92 offen sc1 nt
    s_add_u32 s92, s92, 512
    s_cmp_gt_u32 s99, 6
    s_cbranch_scc0 Lk2_done
    s_cmp_eq_u32 s56, 7
    s_cbranch_scc1 Lfin3
Lcarry3:
    s_waitcnt lgkmcnt(0)
    v_cmp_eq_u32 vcc, 0, v247
    s_cbranch_vccz Lcarried3
    s_sleep 1
    ds_read_b32 v247, v252 offset:4164
    ds_read_b128 v[140:143], v248 offset:2560
    ds_read_b128 v[144:147], v248 offset:3584
    s_branch Lcarry3
Lcarried3:
    s_set_gpr_idx_on s93, gpr_idx(SRC0,DST)
    v_pk_add_f32 v[0:1], v[0:1], v[140:141]
    v_pk_add_f32 v[2:3], v[2:3], v[142:143]
    v_pk_add_f32 v[4:5], v[4:5], v[144:145]
    v_pk_add_f32 v[6:7], v[6:7], v[146:147]
    s_set_gpr_idx_off
    s_nop 1
Lfin3:
    v_permlane32_swap_b32 v84, v96
    v_permlane32_swap_b32 v88, v100
    v_permlane32_swap_b32 v85, v97
    v_permlane32_swap_b32 v89, v101
    v_permlane32_swap_b32 v86, v98
    v_permlane32_swap_b32 v90, v102
    v_permlane32_swap_b32 v87, v99
    v_permlane32_swap_b32 v91, v103
    v_pk_add_f32 v[88:89], v[88:89], v[100:101]
    v_pk_add_f32 v[90:91], v[90:91], v[102:103]
    v_pk_add_f32 v[84:85], v[84:85], v[96:97]
    v_pk_add_f32 v[86:87], v[86:87], v[98:99]
    v_rcp_f32 v88, v88
    v_rcp_f32 v89, v89
    v_rcp_f32 v90, v90
    v_rcp_f32 v91, v91
    v_pk_fma_f32 v[84:85], v[84:85], v[88:89], v[120:121]
    v_pk_fma_f32 v[86:87], v[86:87], v[90:91], v[122:123]
    v_cvt_pk_bf16_f32 v84, v84, v85
    v_cvt_pk_bf16_f32 v85, v86, v87
    v_pk_max_f16 v84, v84, v130
    v_pk_max_f16 v85, v85, v131
    s_cmp_gt_u32 s99, 7
    s_cselect_b32 exec_hi, -1, 0
    buffer_store_dwordx2 v[84:85], v251, s[52:55], s92 offen sc1 nt
Lk2_done:
Lk2_exit:
    s_endpgm
Lcold_code:
Lslow_entry:
    s_cmp_ge_u32 s56, 4
    s_cbranch_scc1 Lg_rows
    v_mov_b32 v96, 0xc2400000
    v_mov_b32 v97, 0xc2400000
    s_mov_b32 s72, s63
    s_mov_b32 s73, s63
    v_pk_fma_f32 v[32:33], v[32:33], s[72:73], v[96:97]
    v_pk_fma_f32 v[34:35], v[34:35], s[72:73], v[96:97]
    v_pk_fma_f32 v[36:37], v[36:37], s[72:73], v[96:97]
    v_pk_fma_f32 v[38:39], v[38:39], s[72:73], v[96:97]
    v_pk_fma_f32 v[40:41], v[40:41], s[72:73], v[96:97]
    v_pk_fma_f32 v[42:43], v[42:43], s[72:73], v[96:97]
    v_pk_fma_f32 v[44:45], v[44:45], s[72:73], v[96:97]
    v_pk_fma_f32 v[46:47], v[46:47], s[72:73], v[96:97]
    v_pk_fma_f32 v[48:49], v[48:49], s[72:73], v[96:97]
    v_pk_fma_f32 v[50:51], v[50:51], s[72:73], v[96:97]
    v_pk_fma_f32 v[52:53], v[52:53], s[72:73], v[96:97]
    v_pk_fma_f32 v[54:55], v[54:55], s[72:73], v[96:97]
    v_pk_fma_f32 v[56:57], v[56:57], s[72:73], v[96:97]
    v_pk_fma_f32 v[58:59], v[58:59], s[72:73], v[96:97]
    v_pk_fma_f32 v[60:61], v[60:61], s[72:73], v[96:97]
    v_pk_fma_f32 v[62:63], v[62:63], s[72:73], v[96:97]
Lg_rows:
    ds_write_b128 v157, v[32:35] offset:0
    ds_write_b128 v157, v[36:39] offset:32
    ds_write_b128 v157, v[40:43] offset:64
    ds_write_b128 v157, v[44:47] offset:96
    s_mov_b32 exec_lo, 0xfffff
    s_mov_b32 exec_hi, 0xfffff
    ds_write_b128 v157, v[48:51] offset:16896
    ds_write_b128 v157, v[52:55] offset:16928
    ds_write_b128 v157, v[56:59] offset:16960
    ds_write_b128 v157, v[60:63] offset:16992
    s_mov_b64 exec, -1
    v_lshrrev_b32 v159, 1, v236
    v_lshl_add_u32 v159, v241, 7, v159
    v_add_u32 v159, 78336, v159
    ds_read_b64 v[108:109], v159 offset:0
    ds_read_b64 v[110:111], v159 offset:256
    ds_read_b64 v[112:113], v159 offset:512
    ds_read_b64 v[114:115], v159 offset:768
    ds_read_b64 v[116:117], v159 offset:1024
    ds_read_b64 v[118:119], v159 offset:1280
    ds_read_b64 v[120:121], v159 offset:1536
    ds_read_b64 v[122:123], v159 offset:1792
    s_waitcnt lgkmcnt(0)
    s_mov_b32 s3, 0x05040100
    s_mov_b32 s72, 0x07060302
    v_perm_b32 v204, v110, v108, s3
    v_perm_b32 v205, v114, v112, s3
    v_perm_b32 v206, v118, v116, s3
    v_perm_b32 v207, v122, v120, s3
    v_perm_b32 v208, v110, v108, s72
    v_perm_b32 v209, v114, v112, s72
    v_perm_b32 v210, v118, v116, s72
    v_perm_b32 v211, v122, v120, s72
    v_perm_b32 v212, v111, v109, s3
    v_perm_b32 v213, v115, v113, s3
    v_perm_b32 v214, v119, v117, s3
    v_perm_b32 v215, v123, v121, s3
    v_perm_b32 v216, v111, v109, s72
    v_perm_b32 v217, v115, v113, s72
    v_perm_b32 v218, v119, v117, s72
    v_perm_b32 v219, v123, v121, s72
    s_waitcnt vmcnt(0) lgkmcnt(0)
    s_barrier
    v_lshlrev_b32 v159, 2, v243
    ds_write_b32 v159, v153 offset:0
    s_mul_i32 s3, s56, 528
    s_add_u32 s3, s3, 97296
    v_add_u32 v159, s3, v236
    ds_read_b128 v[56:59], v159 offset:0
    ds_read_b128 v[60:63], v159 offset:4224
    ds_read_b128 v[64:67], v159 offset:8448
    ds_read_b128 v[68:71], v159 offset:12672
    ds_read_b128 v[72:75], v159 offset:16896
    ds_read_b128 v[76:79], v159 offset:21120
    ds_read_b128 v[80:83], v159 offset:25344
    s_mov_b32 s72, 0x4d0637bd
    s_mov_b32 s73, 0x4d0637bd
    v_mov_b64 v[0:1], 0
    v_mov_b64 v[2:3], 0
    v_mov_b64 v[4:5], s[72:73]
    v_mov_b64 v[6:7], s[72:73]
    v_mov_b64 v[8:9], 0
    v_mov_b64 v[10:11], 0
    v_mov_b64 v[12:13], s[72:73]
    v_mov_b64 v[14:15], s[72:73]
    v_mov_b64 v[16:17], 0
    v_mov_b64 v[18:19], 0
    v_mov_b64 v[20:21], s[72:73]
    v_mov_b64 v[22:23], s[72:73]
    v_mov_b64 v[24:25], 0
    v_mov_b64 v[26:27], 0
    v_mov_b64 v[28:29], s[72:73]
    v_mov_b64 v[30:31], s[72:73]
    v_mov_b64 v[32:33], 0
    v_mov_b64 v[34:35], 0
    v_mov_b64 v[36:37], s[72:73]
    v_mov_b64 v[38:39], s[72:73]
    v_mov_b64 v[40:41], 0
    v_mov_b64 v[42:43], 0
    v_mov_b64 v[44:45], s[72:73]
    v_mov_b64 v[46:47], s[72:73]
    v_mov_b64 v[48:49], 0
    v_mov_b64 v[50:51], 0
    v_mov_b64 v[52:53], s[72:73]
    v_mov_b64 v[54:55], s[72:73]
    v_bfe_u32 v159, v243, 3, 3
    v_and_b32 v160, 7, v243
    v_lshlrev_b32 v160, 2, v160
    v_lshl_add_u32 v160, v159, 8, v160
    s_lshl_b32 s3, s56, 5
    v_add_u32 v254, s3, v160
    v_bfe_u32 v159, v243, 3, 2
    v_bfe_u32 v160, v243, 1, 1
    v_lshl_add_u32 v159, v159, 1, v160
    v_lshlrev_b32 v255, 5, v159
Lbatch:
    v_bfe_u32 v148, v244, 11, 11
    v_and_b32 v149, 1, v243
    v_subrev_u32 v148, s59, v148
    v_lshlrev_b32 v149, 2, v149
    v_cmp_lt_i32_e64 s[70:71], 16, v148
    v_sub_u32 v148, v148, v149
    v_cmp_lt_i32_e64 s[76:77], 0, v148
    v_cmp_lt_i32_e64 s[78:79], 1, v148
    v_cmp_lt_i32_e64 s[80:81], 2, v148
    v_cmp_lt_i32_e64 s[82:83], 3, v148
    v_cmp_lt_i32_e64 s[84:85], 8, v148
    v_cmp_lt_i32_e64 s[86:87], 9, v148
    v_cmp_lt_i32_e64 s[88:89], 10, v148
    v_cmp_lt_i32_e64 s[90:91], 11, v148
Lround:
    v_lshrrev_b32 v150, 1, v243
    v_and_b32 v149, 1, v243
    v_mul_u32_u24 v150, 1568, v150
    v_lshl_add_u32 v149, v149, 2, s59
    v_add_u32 v149, v149, v150
    v_lshlrev_b32 v150, 5, v150
    v_mov_b64 v[116:117], 0
    v_mov_b64 v[118:119], 0
    v_mov_b64 v[120:121], 0
    v_mov_b64 v[122:123], 0
    v_and_b32 v152, 0x7ff, v244
    v_add_lshl_u32 v152, v152, v149, 2
    buffer_load_dwordx4 v[108:111], v152, s[36:39], 0 offen sc1
    buffer_load_dwordx4 v[112:115], v152, s[36:39], 0 offen offset:32 sc1
    v_mov_b32 v153, 0
    v_mov_b32 v154, 1
    ds_write_b32 v153, v153 offset:4096
    ds_write_b32 v153, v153 offset:4100
    s_waitcnt lgkmcnt(0)
    s_barrier
    s_mov_b64 exec, s[70:71]
    ds_write_b32 v153, v154 offset:4100
    s_mov_b64 exec, -1
    s_waitcnt vmcnt(0)
    s_mov_b64 exec, s[76:77]
    v_alignbit_b32 v116, v108, v108, 27
    v_and_b32 v116, 0x7fc, v116
    ds_add_rtn_u32 v124, v116, v154 offset:0
    s_mov_b64 exec, s[78:79]
    v_alignbit_b32 v117, v109, v109, 27
    v_and_b32 v117, 0x7fc, v117
    ds_add_rtn_u32 v125, v117, v154 offset:0
    s_mov_b64 exec, s[80:81]
    v_alignbit_b32 v118, v110, v110, 27
    v_and_b32 v118, 0x7fc, v118
    ds_add_rtn_u32 v126, v118, v154 offset:0
    s_mov_b64 exec, s[82:83]
    v_alignbit_b32 v119, v111, v111, 27
    v_and_b32 v119, 0x7fc, v119
    ds_add_rtn_u32 v127, v119, v154 offset:0
    s_mov_b64 exec, s[84:85]
    v_alignbit_b32 v120, v112, v112, 27
    v_and_b32 v120, 0x7fc, v120
    ds_add_rtn_u32 v128, v120, v154 offset:0
    s_mov_b64 exec, s[86:87]
    v_alignbit_b32 v121, v113, v113, 27
    v_and_b32 v121, 0x7fc, v121
    ds_add_rtn_u32 v129, v121, v154 offset:0
    s_mov_b64 exec, s[88:89]
    v_alignbit_b32 v122, v114, v114, 27
    v_and_b32 v122, 0x7fc, v122
    ds_add_rtn_u32 v130, v122, v154 offset:0
    s_mov_b64 exec, s[90:91]
    v_alignbit_b32 v123, v115, v115, 27
    v_and_b32 v123, 0x7fc, v123
    ds_add_rtn_u32 v131, v123, v154 offset:0
    s_mov_b64 exec, -1
    v_lshrrev_b32 v132, 18, v108
    v_bfe_u32 v140, v108, 6, 12
    v_lshlrev_b32 v132, 9, v132
    v_lshl_add_u32 v140, v140, 5, v150
    v_lshrrev_b32 v133, 18, v109
    v_bfe_u32 v141, v109, 6, 12
    v_lshlrev_b32 v133, 9, v133
    v_lshl_add_u32 v141, v141, 5, v150
    v_lshrrev_b32 v134, 18, v110
    v_bfe_u32 v142, v110, 6, 12
    v_lshlrev_b32 v134, 9, v134
    v_lshl_add_u32 v142, v142, 5, v150
    v_lshrrev_b32 v135, 18, v111
    v_bfe_u32 v143, v111, 6, 12
    v_lshlrev_b32 v135, 9, v135
    v_lshl_add_u32 v143, v143, 5, v150
    v_lshrrev_b32 v136, 18, v112
    v_bfe_u32 v144, v112, 6, 12
    v_lshlrev_b32 v136, 9, v136
    v_lshl_add_u32 v144, v144, 5, v150
    v_lshrrev_b32 v137, 18, v113
    v_bfe_u32 v145, v113, 6, 12
    v_lshlrev_b32 v137, 9, v137
    v_lshl_add_u32 v145, v145, 5, v150
    v_lshrrev_b32 v138, 18, v114
    v_bfe_u32 v146, v114, 6, 12
    v_lshlrev_b32 v138, 9, v138
    v_lshl_add_u32 v146, v146, 5, v150
    v_lshrrev_b32 v139, 18, v115
    v_bfe_u32 v147, v115, 6, 12
    v_lshlrev_b32 v139, 9, v139
    v_lshl_add_u32 v147, v147, 5, v150
    s_waitcnt lgkmcnt(0)
    s_barrier
    ds_read_b32 v160, v254 offset:0
    v_lshrrev_b32 v164, 5, v254
    v_lshlrev_b32 v164, 6, v164
    s_waitcnt lgkmcnt(0)
    ds_write_b32 v254, v153 offset:0
    v_mov_b32 v161, v160
    s_nop 1
    v_add_u32_dpp v161, v161, v161 row_shr:1 row_mask:0xf bank_mask:0xf
    s_nop 1
    v_add_u32_dpp v161, v161, v161 row_shr:2 row_mask:0xf bank_mask:0xf
    s_nop 1
    v_add_u32_dpp v161, v161, v161 row_shr:4 row_mask:0xf bank_mask:0xf
    s_nop 1
    v_add_u32_dpp v161, v161, v161 row_shr:8 row_mask:0xf bank_mask:0xf
    v_mov_b32 v165, 0
    s_nop 0
    v_mov_b32_dpp v162, v161 row_newbcast:7 row_mask:0xf bank_mask:0x3
    v_mov_b32_dpp v165, v161 row_newbcast:7 row_mask:0xf bank_mask:0xc
    v_mov_b32_dpp v162, v161 row_newbcast:15 row_mask:0xf bank_mask:0xc
    v_sub_u32 v161, v161, v165
    v_sub_u32 v162, v162, v165
    v_sub_u32 v161, v161, v160
    v_add_u32 v161, v161, v164
    ds_write_b32 v254, v161 offset:2048
    v_cmp_lt_u32 vcc, 64, v162
    v_min_u32 v162, 64, v162
    v_add_u32 v163, 3, v162
    v_lshrrev_b32 v163, 2, v163
    s_mov_b64 exec, vcc
    ds_write_b32 v153, v154 offset:4096
    s_mov_b64 exec, -1
    ds_bpermute_b32 v253, v255, v163
    v_and_b32 v160, 7, v243
    v_add_u32 v160, v160, v162
    v_lshlrev_b32 v165, 2, v163
    v_cmp_lt_u32 vcc, v160, v165
    v_add_lshl_u32 v160, v160, v164, 2
    v_mov_b32 v164, 6400000
    v_bfrev_b32 v165, 2
    s_mov_b64 exec, vcc
    ds_write_b32 v160, v164 offset:12800
    ds_write_b32 v160, v165 offset:38400
    s_mov_b64 exec, -1
    v_max_u32_dpp v163, v163, v163 row_ror:8 row_mask:0xf bank_mask:0xf
    s_nop 0
    v_readlane_b32 s60, v163, 0
    v_readlane_b32 s3, v163, 16
    v_readlane_b32 s72, v163, 32
    v_readlane_b32 s73, v163, 48
    s_waitcnt lgkmcnt(0)
    s_barrier
    ds_read_b64 v[160:161], v153 offset:4096
    ds_read_b32 v116, v116 offset:2048
    ds_read_b32 v117, v117 offset:2048
    ds_read_b32 v118, v118 offset:2048
    ds_read_b32 v119, v119 offset:2048
    ds_read_b32 v120, v120 offset:2048
    ds_read_b32 v121, v121 offset:2048
    ds_read_b32 v122, v122 offset:2048
    ds_read_b32 v123, v123 offset:2048
    s_max_u32 s60, s60, s3
    s_max_u32 s72, s72, s73
    s_max_u32 s60, s60, s72
    s_waitcnt lgkmcnt(0)
    v_readfirstlane_b32 s92, v160
    v_readfirstlane_b32 s93, v161
    v_and_b32 v160, 63, v108
    v_add_u32 v116, v116, v124
    v_lshl_add_u32 v160, v160, 6, 64
    v_cmp_lt_u32 vcc, v116, v160
    v_lshlrev_b32 v116, 2, v116
    s_and_b64 exec, vcc, s[76:77]
    ds_write_b32 v116, v132 offset:12800
    ds_write_b32 v116, v140 offset:38400
    s_andn2_b64 s[76:77], s[76:77], vcc
    s_mov_b64 exec, -1
    v_and_b32 v160, 63, v109
    v_add_u32 v117, v117, v125
    v_lshl_add_u32 v160, v160, 6, 64
    v_cmp_lt_u32 vcc, v117, v160
    v_lshlrev_b32 v117, 2, v117
    s_and_b64 exec, vcc, s[78:79]
    ds_write_b32 v117, v133 offset:12800
    ds_write_b32 v117, v141 offset:38400
    s_andn2_b64 s[78:79], s[78:79], vcc
    s_mov_b64 exec, -1
    v_and_b32 v160, 63, v110
    v_add_u32 v118, v118, v126
    v_lshl_add_u32 v160, v160, 6, 64
    v_cmp_lt_u32 vcc, v118, v160
    v_lshlrev_b32 v118, 2, v118
    s_and_b64 exec, vcc, s[80:81]
    ds_write_b32 v118, v134 offset:12800
    ds_write_b32 v118, v142 offset:38400
    s_andn2_b64 s[80:81], s[80:81], vcc
    s_mov_b64 exec, -1
    v_and_b32 v160, 63, v111
    v_add_u32 v119, v119, v127
    v_lshl_add_u32 v160, v160, 6, 64
    v_cmp_lt_u32 vcc, v119, v160
    v_lshlrev_b32 v119, 2, v119
    s_and_b64 exec, vcc, s[82:83]
    ds_write_b32 v119, v135 offset:12800
    ds_write_b32 v119, v143 offset:38400
    s_andn2_b64 s[82:83], s[82:83], vcc
    s_mov_b64 exec, -1
    v_and_b32 v160, 63, v112
    v_add_u32 v120, v120, v128
    v_lshl_add_u32 v160, v160, 6, 64
    v_cmp_lt_u32 vcc, v120, v160
    v_lshlrev_b32 v120, 2, v120
    s_and_b64 exec, vcc, s[84:85]
    ds_write_b32 v120, v136 offset:12800
    ds_write_b32 v120, v144 offset:38400
    s_andn2_b64 s[84:85], s[84:85], vcc
    s_mov_b64 exec, -1
    v_and_b32 v160, 63, v113
    v_add_u32 v121, v121, v129
    v_lshl_add_u32 v160, v160, 6, 64
    v_cmp_lt_u32 vcc, v121, v160
    v_lshlrev_b32 v121, 2, v121
    s_and_b64 exec, vcc, s[86:87]
    ds_write_b32 v121, v137 offset:12800
    ds_write_b32 v121, v145 offset:38400
    s_andn2_b64 s[86:87], s[86:87], vcc
    s_mov_b64 exec, -1
    v_and_b32 v160, 63, v114
    v_add_u32 v122, v122, v130
    v_lshl_add_u32 v160, v160, 6, 64
    v_cmp_lt_u32 vcc, v122, v160
    v_lshlrev_b32 v122, 2, v122
    s_and_b64 exec, vcc, s[88:89]
    ds_write_b32 v122, v138 offset:12800
    ds_write_b32 v122, v146 offset:38400
    s_andn2_b64 s[88:89], s[88:89], vcc
    s_mov_b64 exec, -1
    v_and_b32 v160, 63, v115
    v_add_u32 v123, v123, v131
    v_lshl_add_u32 v160, v160, 6, 64
    v_cmp_lt_u32 vcc, v123, v160
    v_lshlrev_b32 v123, 2, v123
    s_and_b64 exec, vcc, s[90:91]
    ds_write_b32 v123, v139 offset:12800
    ds_write_b32 v123, v147 offset:38400
    s_andn2_b64 s[90:91], s[90:91], vcc
    s_mov_b64 exec, -1
    s_lshl_b32 s3, s56, 8
    v_lshrrev_b32 v160, 1, v241
    v_add_u32 v245, s3, v160
    v_and_b32 v160, 1, v243
    v_bfe_u32 v161, v243, 2, 1
    v_lshl_add_u32 v160, v161, 1, v160
    v_lshl_add_u32 v160, v160, 2, s3
    v_lshl_add_u32 v239, v255, 6, v160
    s_lshr_b32 s3, s60, 1
    v_mov_b32 v252, s3
    s_mov_b64 s[66:67], 0
    s_mov_b32 s61, 0
    v_mov_b32 v246, v245
    v_mov_b32 v247, v245
    v_mov_b32 v248, v245
    v_mov_b32 v249, v245
    v_mov_b32 v250, v245
    v_mov_b32 v251, v245
    s_waitcnt lgkmcnt(0)
    s_barrier
    s_cmp_eq_u32 s60, 0
    s_cbranch_scc1 Lg_done
    s_branch Lg_entry
Lg_tile:
    s_waitcnt vmcnt(14)
    v_mfma_f32_32x32x16_bf16 v[108:123], v[220:223], v[204:207], 0
    v_mfma_f32_32x32x16_bf16 v[124:139], v[220:223], v[208:211], 0
    v_mfma_f32_32x32x16_bf16 v[140:155], v[220:223], v[212:215], 0
    v_mfma_f32_32x32x16_bf16 v[156:171], v[220:223], v[216:219], 0
Lg_entry:
    v_add_u32 v252, v253, v252
    ds_read_b32 v240, v239 offset:38400
    ds_read_b64 v[232:233], v245 offset:12800
    v_cmp_le_u32_e64 s[68:69], s60, v252
    s_cmp_lt_u32 s61, s60
    s_cselect_b64 s[68:69], s[68:69], 1
    s_mov_b64 exec, s[68:69]
    v_subrev_u32 v252, s60, v252
    v_add_u32 v239, 16, v239
    s_waitcnt lgkmcnt(1)
    v_add_u32 v240, v240, v241
    buffer_load_dwordx4 v[220:223], v240, s[32:35], 0 offen
    s_mov_b64 exec, -1
    ds_read_b64 v[234:235], v246 offset:14848
    s_bitcmp1_b32 s66, 1
    s_cbranch_scc0 Lg_skip0
    s_waitcnt vmcnt(13)
    v_fma_mix_f32 v224, v108, s63, v172 op_sel_hi:[0,0,1]
    v_fma_mix_f32 v225, v124, s63, v173 op_sel_hi:[0,0,1]
    v_fma_mix_f32 v226, v140, s63, v174 op_sel_hi:[0,0,1]
    v_fma_mix_f32 v227, v156, s63, v175 op_sel_hi:[0,0,1]
    v_fma_mix_f32 v228, v109, s63, v176 op_sel_hi:[0,0,1]
    v_fma_mix_f32 v229, v125, s63, v177 op_sel_hi:[0,0,1]
    v_fma_mix_f32 v230, v141, s63, v178 op_sel_hi:[0,0,1]
    v_fma_mix_f32 v231, v157, s63, v179 op_sel_hi:[0,0,1]
    v_pk_add_f32 v[224:225], v[224:225], v[56:57]
    v_pk_add_f32 v[226:227], v[226:227], v[58:59]
    v_pk_add_f32 v[228:229], v[228:229], v[56:57]
    v_pk_add_f32 v[230:231], v[230:231], v[58:59]
    v_exp_f32_e64 v224, v224 clamp
    v_exp_f32_e64 v225, v225 clamp
    v_exp_f32_e64 v226, v226 clamp
    v_exp_f32_e64 v227, v227 clamp
    v_exp_f32_e64 v228, v228 clamp
    v_exp_f32_e64 v229, v229 clamp
    v_exp_f32_e64 v230, v230 clamp
    v_exp_f32_e64 v231, v231 clamp
    v_pk_add_f32 v[224:225], v[224:225], s[64:65]
    v_pk_add_f32 v[226:227], v[226:227], s[64:65]
    v_pk_add_f32 v[228:229], v[228:229], s[64:65]
    v_pk_add_f32 v[230:231], v[230:231], s[64:65]
    v_pk_mul_f32 v[172:173], v[172:173], v[228:229]
    v_pk_mul_f32 v[174:175], v[174:175], v[230:231]
    v_pk_fma_f32 v[172:173], v[176:177], v[224:225], v[172:173]
    v_pk_fma_f32 v[174:175], v[178:179], v[226:227], v[174:175]
    v_pk_add_f32 v[176:177], v[224:225], v[228:229]
    v_pk_add_f32 v[178:179], v[226:227], v[230:231]
    v_pk_mul_f32 v[224:225], v[224:225], v[228:229]
    v_pk_mul_f32 v[226:227], v[226:227], v[230:231]
    v_rcp_f32 v224, v224
    v_rcp_f32 v225, v225
    v_rcp_f32 v226, v226
    v_rcp_f32 v227, v227
    v_pk_fma_f32 v[0:1], v[172:173], v[224:225], v[0:1]
    v_pk_fma_f32 v[4:5], v[176:177], v[224:225], v[4:5]
    v_pk_fma_f32 v[2:3], v[174:175], v[226:227], v[2:3]
    v_pk_fma_f32 v[6:7], v[178:179], v[226:227], v[6:7]
Lg_skip0:
    s_bitcmp1_b32 s68, 1
    s_cselect_b64 exec, -1, 1
    s_cselect_b32 s62, 16, 0
    s_waitcnt lgkmcnt(1)
    v_add_u32 v232, v232, v236
    v_add_u32 v233, v233, v236
    buffer_load_dwordx4 v[172:175], v232, s[28:31], 0 offen sc1
    buffer_load_dwordx4 v[176:179], v233, s[28:31], 0 offen sc1
    s_mov_b64 exec, -1
    v_add_u32 v245, s62, v245
    ds_read_b64 v[232:233], v247 offset:16896
    s_bitcmp1_b32 s66, 3
    s_cbranch_scc0 Lg_skip1
    s_waitcnt vmcnt(13)
    v_fma_mix_f32 v224, v110, s63, v180 op_sel_hi:[0,0,1]
    v_fma_mix_f32 v225, v126, s63, v181 op_sel_hi:[0,0,1]
    v_fma_mix_f32 v226, v142, s63, v182 op_sel_hi:[0,0,1]
    v_fma_mix_f32 v227, v158, s63, v183 op_sel_hi:[0,0,1]
    v_fma_mix_f32 v228, v111, s63, v184 op_sel_hi:[0,0,1]
    v_fma_mix_f32 v229, v127, s63, v185 op_sel_hi:[0,0,1]
    v_fma_mix_f32 v230, v143, s63, v186 op_sel_hi:[0,0,1]
    v_fma_mix_f32 v231, v159, s63, v187 op_sel_hi:[0,0,1]
    v_pk_add_f32 v[224:225], v[224:225], v[60:61]
    v_pk_add_f32 v[226:227], v[226:227], v[62:63]
    v_pk_add_f32 v[228:229], v[228:229], v[60:61]
    v_pk_add_f32 v[230:231], v[230:231], v[62:63]
    v_exp_f32_e64 v224, v224 clamp
    v_exp_f32_e64 v225, v225 clamp
    v_exp_f32_e64 v226, v226 clamp
    v_exp_f32_e64 v227, v227 clamp
    v_exp_f32_e64 v228, v228 clamp
    v_exp_f32_e64 v229, v229 clamp
    v_exp_f32_e64 v230, v230 clamp
    v_exp_f32_e64 v231, v231 clamp
    v_pk_add_f32 v[224:225], v[224:225], s[64:65]
    v_pk_add_f32 v[226:227], v[226:227], s[64:65]
    v_pk_add_f32 v[228:229], v[228:229], s[64:65]
    v_pk_add_f32 v[230:231], v[230:231], s[64:65]
    v_pk_mul_f32 v[180:181], v[180:181], v[228:229]
    v_pk_mul_f32 v[182:183], v[182:183], v[230:231]
    v_pk_fma_f32 v[180:181], v[184:185], v[224:225], v[180:181]
    v_pk_fma_f32 v[182:183], v[186:187], v[226:227], v[182:183]
    v_pk_add_f32 v[184:185], v[224:225], v[228:229]
    v_pk_add_f32 v[186:187], v[226:227], v[230:231]
    v_pk_mul_f32 v[224:225], v[224:225], v[228:229]
    v_pk_mul_f32 v[226:227], v[226:227], v[230:231]
    v_rcp_f32 v224, v224
    v_rcp_f32 v225, v225
    v_rcp_f32 v226, v226
    v_rcp_f32 v227, v227
    v_pk_fma_f32 v[8:9], v[180:181], v[224:225], v[8:9]
    v_pk_fma_f32 v[12:13], v[184:185], v[224:225], v[12:13]
    v_pk_fma_f32 v[10:11], v[182:183], v[226:227], v[10:11]
    v_pk_fma_f32 v[14:15], v[186:187], v[226:227], v[14:15]
Lg_skip1:
    s_bitcmp1_b32 s68, 3
    s_cselect_b64 exec, -1, 1
    s_cselect_b32 s62, 16, 0
    s_waitcnt lgkmcnt(1)
    v_add_u32 v234, v234, v236
    v_add_u32 v235, v235, v236
    buffer_load_dwordx4 v[180:183], v234, s[28:31], 0 offen sc1
    buffer_load_dwordx4 v[184:187], v235, s[28:31], 0 offen sc1
    s_mov_b64 exec, -1
    v_add_u32 v246, s62, v246
    ds_read_b64 v[234:235], v248 offset:18944
    s_bitcmp1_b32 s66, 9
    s_cbranch_scc0 Lg_skip2
    s_waitcnt vmcnt(13)
    v_fma_mix_f32 v224, v112, s63, v188 op_sel_hi:[0,0,1]
    v_fma_mix_f32 v225, v128, s63, v189 op_sel_hi:[0,0,1]
    v_fma_mix_f32 v226, v144, s63, v190 op_sel_hi:[0,0,1]
    v_fma_mix_f32 v227, v160, s63, v191 op_sel_hi:[0,0,1]
    v_fma_mix_f32 v228, v113, s63, v192 op_sel_hi:[0,0,1]
    v_fma_mix_f32 v229, v129, s63, v193 op_sel_hi:[0,0,1]
    v_fma_mix_f32 v230, v145, s63, v194 op_sel_hi:[0,0,1]
    v_fma_mix_f32 v231, v161, s63, v195 op_sel_hi:[0,0,1]
    v_pk_add_f32 v[224:225], v[224:225], v[64:65]
    v_pk_add_f32 v[226:227], v[226:227], v[66:67]
    v_pk_add_f32 v[228:229], v[228:229], v[64:65]
    v_pk_add_f32 v[230:231], v[230:231], v[66:67]
    v_exp_f32_e64 v224, v224 clamp
    v_exp_f32_e64 v225, v225 clamp
    v_exp_f32_e64 v226, v226 clamp
    v_exp_f32_e64 v227, v227 clamp
    v_exp_f32_e64 v228, v228 clamp
    v_exp_f32_e64 v229, v229 clamp
    v_exp_f32_e64 v230, v230 clamp
    v_exp_f32_e64 v231, v231 clamp
    v_pk_add_f32 v[224:225], v[224:225], s[64:65]
    v_pk_add_f32 v[226:227], v[226:227], s[64:65]
    v_pk_add_f32 v[228:229], v[228:229], s[64:65]
    v_pk_add_f32 v[230:231], v[230:231], s[64:65]
    v_pk_mul_f32 v[188:189], v[188:189], v[228:229]
    v_pk_mul_f32 v[190:191], v[190:191], v[230:231]
    v_pk_fma_f32 v[188:189], v[192:193], v[224:225], v[188:189]
    v_pk_fma_f32 v[190:191], v[194:195], v[226:227], v[190:191]
    v_pk_add_f32 v[192:193], v[224:225], v[228:229]
    v_pk_add_f32 v[194:195], v[226:227], v[230:231]
    v_pk_mul_f32 v[224:225], v[224:225], v[228:229]
    v_pk_mul_f32 v[226:227], v[226:227], v[230:231]
    v_rcp_f32 v224, v224
    v_rcp_f32 v225, v225
    v_rcp_f32 v226, v226
    v_rcp_f32 v227, v227
    v_pk_fma_f32 v[16:17], v[188:189], v[224:225], v[16:17]
    v_pk_fma_f32 v[20:21], v[192:193], v[224:225], v[20:21]
    v_pk_fma_f32 v[18:19], v[190:191], v[226:227], v[18:19]
    v_pk_fma_f32 v[22:23], v[194:195], v[226:227], v[22:23]
Lg_skip2:
    s_bitcmp1_b32 s68, 9
    s_cselect_b64 exec, -1, 1
    s_cselect_b32 s62, 16, 0
    s_waitcnt lgkmcnt(1)
    v_add_u32 v232, v232, v236
    v_add_u32 v233, v233, v236
    buffer_load_dwordx4 v[188:191], v232, s[28:31], 0 offen sc1
    buffer_load_dwordx4 v[192:195], v233, s[28:31], 0 offen sc1
    s_mov_b64 exec, -1
    v_add_u32 v247, s62, v247
    ds_read_b64 v[232:233], v249 offset:20992
    s_bitcmp1_b32 s66, 11
    s_cbranch_scc0 Lg_skip3
    s_waitcnt vmcnt(13)
    v_fma_mix_f32 v224, v114, s63, v196 op_sel_hi:[0,0,1]
    v_fma_mix_f32 v225, v130, s63, v197 op_sel_hi:[0,0,1]
    v_fma_mix_f32 v226, v146, s63, v198 op_sel_hi:[0,0,1]
    v_fma_mix_f32 v227, v162, s63, v199 op_sel_hi:[0,0,1]
    v_fma_mix_f32 v228, v115, s63, v200 op_sel_hi:[0,0,1]
    v_fma_mix_f32 v229, v131, s63, v201 op_sel_hi:[0,0,1]
    v_fma_mix_f32 v230, v147, s63, v202 op_sel_hi:[0,0,1]
    v_fma_mix_f32 v231, v163, s63, v203 op_sel_hi:[0,0,1]
    v_pk_add_f32 v[224:225], v[224:225], v[68:69]
    v_pk_add_f32 v[226:227], v[226:227], v[70:71]
    v_pk_add_f32 v[228:229], v[228:229], v[68:69]
    v_pk_add_f32 v[230:231], v[230:231], v[70:71]
    v_exp_f32_e64 v224, v224 clamp
    v_exp_f32_e64 v225, v225 clamp
    v_exp_f32_e64 v226, v226 clamp
    v_exp_f32_e64 v227, v227 clamp
    v_exp_f32_e64 v228, v228 clamp
    v_exp_f32_e64 v229, v229 clamp
    v_exp_f32_e64 v230, v230 clamp
    v_exp_f32_e64 v231, v231 clamp
    v_pk_add_f32 v[224:225], v[224:225], s[64:65]
    v_pk_add_f32 v[226:227], v[226:227], s[64:65]
    v_pk_add_f32 v[228:229], v[228:229], s[64:65]
    v_pk_add_f32 v[230:231], v[230:231], s[64:65]
    v_pk_mul_f32 v[196:197], v[196:197], v[228:229]
    v_pk_mul_f32 v[198:199], v[198:199], v[230:231]
    v_pk_fma_f32 v[196:197], v[200:201], v[224:225], v[196:197]
    v_pk_fma_f32 v[198:199], v[202:203], v[226:227], v[198:199]
    v_pk_add_f32 v[200:201], v[224:225], v[228:229]
    v_pk_add_f32 v[202:203], v[226:227], v[230:231]
    v_pk_mul_f32 v[224:225], v[224:225], v[228:229]
    v_pk_mul_f32 v[226:227], v[226:227], v[230:231]
    v_rcp_f32 v224, v224
    v_rcp_f32 v225, v225
    v_rcp_f32 v226, v226
    v_rcp_f32 v227, v227
    v_pk_fma_f32 v[24:25], v[196:197], v[224:225], v[24:25]
    v_pk_fma_f32 v[28:29], v[200:201], v[224:225], v[28:29]
    v_pk_fma_f32 v[26:27], v[198:199], v[226:227], v[26:27]
    v_pk_fma_f32 v[30:31], v[202:203], v[226:227], v[30:31]
Lg_skip3:
    s_bitcmp1_b32 s68, 11
    s_cselect_b64 exec, -1, 1
    s_cselect_b32 s62, 16, 0
    s_waitcnt lgkmcnt(1)
    v_add_u32 v234, v234, v236
    v_add_u32 v235, v235, v236
    buffer_load_dwordx4 v[196:199], v234, s[28:31], 0 offen sc1
    buffer_load_dwordx4 v[200:203], v235, s[28:31], 0 offen sc1
    s_mov_b64 exec, -1
    v_add_u32 v248, s62, v248
    ds_read_b64 v[234:235], v250 offset:23040
    s_bitcmp1_b32 s66, 17
    s_cbranch_scc0 Lg_skip4
    s_waitcnt vmcnt(13)
    v_fma_mix_f32 v224, v116, s63, v84 op_sel_hi:[0,0,1]
    v_fma_mix_f32 v225, v132, s63, v85 op_sel_hi:[0,0,1]
    v_fma_mix_f32 v226, v148, s63, v86 op_sel_hi:[0,0,1]
    v_fma_mix_f32 v227, v164, s63, v87 op_sel_hi:[0,0,1]
    v_fma_mix_f32 v228, v117, s63, v88 op_sel_hi:[0,0,1]
    v_fma_mix_f32 v229, v133, s63, v89 op_sel_hi:[0,0,1]
    v_fma_mix_f32 v230, v149, s63, v90 op_sel_hi:[0,0,1]
    v_fma_mix_f32 v231, v165, s63, v91 op_sel_hi:[0,0,1]
    v_pk_add_f32 v[224:225], v[224:225], v[72:73]
    v_pk_add_f32 v[226:227], v[226:227], v[74:75]
    v_pk_add_f32 v[228:229], v[228:229], v[72:73]
    v_pk_add_f32 v[230:231], v[230:231], v[74:75]
    v_exp_f32_e64 v224, v224 clamp
    v_exp_f32_e64 v225, v225 clamp
    v_exp_f32_e64 v226, v226 clamp
    v_exp_f32_e64 v227, v227 clamp
    v_exp_f32_e64 v228, v228 clamp
    v_exp_f32_e64 v229, v229 clamp
    v_exp_f32_e64 v230, v230 clamp
    v_exp_f32_e64 v231, v231 clamp
    v_pk_add_f32 v[224:225], v[224:225], s[64:65]
    v_pk_add_f32 v[226:227], v[226:227], s[64:65]
    v_pk_add_f32 v[228:229], v[228:229], s[64:65]
    v_pk_add_f32 v[230:231], v[230:231], s[64:65]
    v_pk_mul_f32 v[84:85], v[84:85], v[228:229]
    v_pk_mul_f32 v[86:87], v[86:87], v[230:231]
    v_pk_fma_f32 v[84:85], v[88:89], v[224:225], v[84:85]
    v_pk_fma_f32 v[86:87], v[90:91], v[226:227], v[86:87]
    v_pk_add_f32 v[88:89], v[224:225], v[228:229]
    v_pk_add_f32 v[90:91], v[226:227], v[230:231]
    v_pk_mul_f32 v[224:225], v[224:225], v[228:229]
    v_pk_mul_f32 v[226:227], v[226:227], v[230:231]
    v_rcp_f32 v224, v224
    v_rcp_f32 v225, v225
    v_rcp_f32 v226, v226
    v_rcp_f32 v227, v227
    v_pk_fma_f32 v[32:33], v[84:85], v[224:225], v[32:33]
    v_pk_fma_f32 v[36:37], v[88:89], v[224:225], v[36:37]
    v_pk_fma_f32 v[34:35], v[86:87], v[226:227], v[34:35]
    v_pk_fma_f32 v[38:39], v[90:91], v[226:227], v[38:39]
Lg_skip4:
    s_bitcmp1_b32 s68, 17
    s_cselect_b64 exec, -1, 1
    s_cselect_b32 s62, 16, 0
    s_waitcnt lgkmcnt(1)
    v_add_u32 v232, v232, v236
    v_add_u32 v233, v233, v236
    buffer_load_dwordx4 v[84:87], v232, s[28:31], 0 offen sc1
    buffer_load_dwordx4 v[88:91], v233, s[28:31], 0 offen sc1
    s_mov_b64 exec, -1
    v_add_u32 v249, s62, v249
    ds_read_b64 v[232:233], v251 offset:25088
    s_bitcmp1_b32 s66, 19
    s_cbranch_scc0 Lg_skip5
    s_waitcnt vmcnt(13)
    v_fma_mix_f32 v224, v118, s63, v92 op_sel_hi:[0,0,1]
    v_fma_mix_f32 v225, v134, s63, v93 op_sel_hi:[0,0,1]
    v_fma_mix_f32 v226, v150, s63, v94 op_sel_hi:[0,0,1]
    v_fma_mix_f32 v227, v166, s63, v95 op_sel_hi:[0,0,1]
    v_fma_mix_f32 v228, v119, s63, v96 op_sel_hi:[0,0,1]
    v_fma_mix_f32 v229, v135, s63, v97 op_sel_hi:[0,0,1]
    v_fma_mix_f32 v230, v151, s63, v98 op_sel_hi:[0,0,1]
    v_fma_mix_f32 v231, v167, s63, v99 op_sel_hi:[0,0,1]
    v_pk_add_f32 v[224:225], v[224:225], v[76:77]
    v_pk_add_f32 v[226:227], v[226:227], v[78:79]
    v_pk_add_f32 v[228:229], v[228:229], v[76:77]
    v_pk_add_f32 v[230:231], v[230:231], v[78:79]
    v_exp_f32_e64 v224, v224 clamp
    v_exp_f32_e64 v225, v225 clamp
    v_exp_f32_e64 v226, v226 clamp
    v_exp_f32_e64 v227, v227 clamp
    v_exp_f32_e64 v228, v228 clamp
    v_exp_f32_e64 v229, v229 clamp
    v_exp_f32_e64 v230, v230 clamp
    v_exp_f32_e64 v231, v231 clamp
    v_pk_add_f32 v[224:225], v[224:225], s[64:65]
    v_pk_add_f32 v[226:227], v[226:227], s[64:65]
    v_pk_add_f32 v[228:229], v[228:229], s[64:65]
    v_pk_add_f32 v[230:231], v[230:231], s[64:65]
    v_pk_mul_f32 v[92:93], v[92:93], v[228:229]
    v_pk_mul_f32 v[94:95], v[94:95], v[230:231]
    v_pk_fma_f32 v[92:93], v[96:97], v[224:225], v[92:93]
    v_pk_fma_f32 v[94:95], v[98:99], v[226:227], v[94:95]
    v_pk_add_f32 v[96:97], v[224:225], v[228:229]
    v_pk_add_f32 v[98:99], v[226:227], v[230:231]
    v_pk_mul_f32 v[224:225], v[224:225], v[228:229]
    v_pk_mul_f32 v[226:227], v[226:227], v[230:231]
    v_rcp_f32 v224, v224
    v_rcp_f32 v225, v225
    v_rcp_f32 v226, v226
    v_rcp_f32 v227, v227
    v_pk_fma_f32 v[40:41], v[92:93], v[224:225], v[40:41]
    v_pk_fma_f32 v[44:45], v[96:97], v[224:225], v[44:45]
    v_pk_fma_f32 v[42:43], v[94:95], v[226:227], v[42:43]
    v_pk_fma_f32 v[46:47], v[98:99], v[226:227], v[46:47]
Lg_skip5:
    s_bitcmp1_b32 s68, 19
    s_cselect_b64 exec, -1, 1
    s_cselect_b32 s62, 16, 0
    s_waitcnt lgkmcnt(1)
    v_add_u32 v234, v234, v236
    v_add_u32 v235, v235, v236
    buffer_load_dwordx4 v[92:95], v234, s[28:31], 0 offen sc1
    buffer_load_dwordx4 v[96:99], v235, s[28:31], 0 offen sc1
    s_mov_b64 exec, -1
    v_add_u32 v250, s62, v250
    s_bitcmp1_b32 s66, 25
    s_cbranch_scc0 Lg_skip6
    s_waitcnt vmcnt(13)
    v_fma_mix_f32 v224, v120, s63, v100 op_sel_hi:[0,0,1]
    v_fma_mix_f32 v225, v136, s63, v101 op_sel_hi:[0,0,1]
    v_fma_mix_f32 v226, v152, s63, v102 op_sel_hi:[0,0,1]
    v_fma_mix_f32 v227, v168, s63, v103 op_sel_hi:[0,0,1]
    v_fma_mix_f32 v228, v121, s63, v104 op_sel_hi:[0,0,1]
    v_fma_mix_f32 v229, v137, s63, v105 op_sel_hi:[0,0,1]
    v_fma_mix_f32 v230, v153, s63, v106 op_sel_hi:[0,0,1]
    v_fma_mix_f32 v231, v169, s63, v107 op_sel_hi:[0,0,1]
    v_pk_add_f32 v[224:225], v[224:225], v[80:81]
    v_pk_add_f32 v[226:227], v[226:227], v[82:83]
    v_pk_add_f32 v[228:229], v[228:229], v[80:81]
    v_pk_add_f32 v[230:231], v[230:231], v[82:83]
    v_exp_f32_e64 v224, v224 clamp
    v_exp_f32_e64 v225, v225 clamp
    v_exp_f32_e64 v226, v226 clamp
    v_exp_f32_e64 v227, v227 clamp
    v_exp_f32_e64 v228, v228 clamp
    v_exp_f32_e64 v229, v229 clamp
    v_exp_f32_e64 v230, v230 clamp
    v_exp_f32_e64 v231, v231 clamp
    v_pk_add_f32 v[224:225], v[224:225], s[64:65]
    v_pk_add_f32 v[226:227], v[226:227], s[64:65]
    v_pk_add_f32 v[228:229], v[228:229], s[64:65]
    v_pk_add_f32 v[230:231], v[230:231], s[64:65]
    v_pk_mul_f32 v[100:101], v[100:101], v[228:229]
    v_pk_mul_f32 v[102:103], v[102:103], v[230:231]
    v_pk_fma_f32 v[100:101], v[104:105], v[224:225], v[100:101]
    v_pk_fma_f32 v[102:103], v[106:107], v[226:227], v[102:103]
    v_pk_add_f32 v[104:105], v[224:225], v[228:229]
    v_pk_add_f32 v[106:107], v[226:227], v[230:231]
    v_pk_mul_f32 v[224:225], v[224:225], v[228:229]
    v_pk_mul_f32 v[226:227], v[226:227], v[230:231]
    v_rcp_f32 v224, v224
    v_rcp_f32 v225, v225
    v_rcp_f32 v226, v226
    v_rcp_f32 v227, v227
    v_pk_fma_f32 v[48:49], v[100:101], v[224:225], v[48:49]
    v_pk_fma_f32 v[52:53], v[104:105], v[224:225], v[52:53]
    v_pk_fma_f32 v[50:51], v[102:103], v[226:227], v[50:51]
    v_pk_fma_f32 v[54:55], v[106:107], v[226:227], v[54:55]
Lg_skip6:
    s_bitcmp1_b32 s68, 25
    s_cselect_b64 exec, -1, 1
    s_cselect_b32 s62, 16, 0
    s_waitcnt lgkmcnt(0)
    v_add_u32 v232, v232, v236
    v_add_u32 v233, v233, v236
    buffer_load_dwordx4 v[100:103], v232, s[28:31], 0 offen sc1
    buffer_load_dwordx4 v[104:107], v233, s[28:31], 0 offen sc1
    s_mov_b64 exec, -1
    v_add_u32 v251, s62, v251
    s_mov_b64 s[66:67], s[68:69]
    s_add_u32 s61, s61, 1
    s_cmp_le_u32 s61, s60
    s_cbranch_scc1 Lg_tile
Lg_done:
    s_waitcnt vmcnt(0)
    s_cmp_lg_u32 s92, 0
    s_cbranch_scc1 Lround
    s_add_u32 s59, s59, 16
    s_cmp_lg_u32 s93, 0
    s_cbranch_scc1 Lbatch
    s_mul_i32 s3, s56, 528
    s_add_u32 s3, s3, 124752
    v_mul_u32_u24 v133, 264, v241
    v_add3_u32 v133, v133, v236, s3
    s_mul_i32 s3, s56, 272
    s_add_u32 s3, s3, 82432
    v_mul_u32_u24 v134, 136, v241
    v_lshrrev_b32 v237, 1, v236
    v_add3_u32 v134, v134, v237, s3
    ds_read_b128 v[108:111], v133 offset:0
    ds_read_b64 v[124:125], v134 offset:0
    ds_read_b128 v[112:115], v133 offset:8448
    ds_read_b64 v[126:127], v134 offset:4352
    ds_read_b128 v[116:119], v133 offset:16896
    ds_read_b64 v[128:129], v134 offset:8704
    ds_read_b128 v[120:123], v133 offset:25344
    ds_read_b64 v[130:131], v134 offset:13056
    v_lshl_add_u32 v133, v241, 7, v237
    s_add_u32 s94, s58, s56
    s_lshl_b32 s94, s94, 8
    s_waitcnt lgkmcnt(0)
    v_permlane32_swap_b32 v0, v8
    v_permlane32_swap_b32 v4, v12
    v_permlane32_swap_b32 v1, v9
    v_permlane32_swap_b32 v5, v13
    v_permlane32_swap_b32 v2, v10
    v_permlane32_swap_b32 v6, v14
    v_permlane32_swap_b32 v3, v11
    v_permlane32_swap_b32 v7, v15
    v_pk_add_f32 v[4:5], v[4:5], v[12:13]
    v_pk_add_f32 v[6:7], v[6:7], v[14:15]
    v_pk_add_f32 v[0:1], v[0:1], v[8:9]
    v_pk_add_f32 v[2:3], v[2:3], v[10:11]
    v_rcp_f32 v4, v4
    v_rcp_f32 v5, v5
    v_rcp_f32 v6, v6
    v_rcp_f32 v7, v7
    v_pk_fma_f32 v[0:1], v[0:1], v[4:5], v[108:109]
    v_pk_fma_f32 v[2:3], v[2:3], v[6:7], v[110:111]
    v_cvt_pk_bf16_f32 v0, v0, v1
    v_cvt_pk_bf16_f32 v1, v2, v3
    v_pk_max_f16 v0, v0, v124
    v_pk_max_f16 v1, v1, v125
    s_nop 0
    buffer_store_dwordx2 v[0:1], v133, s[52:55], s94 offen sc1 nt
    s_add_u32 s94, s94, 4096
    v_permlane32_swap_b32 v16, v24
    v_permlane32_swap_b32 v20, v28
    v_permlane32_swap_b32 v17, v25
    v_permlane32_swap_b32 v21, v29
    v_permlane32_swap_b32 v18, v26
    v_permlane32_swap_b32 v22, v30
    v_permlane32_swap_b32 v19, v27
    v_permlane32_swap_b32 v23, v31
    v_pk_add_f32 v[20:21], v[20:21], v[28:29]
    v_pk_add_f32 v[22:23], v[22:23], v[30:31]
    v_pk_add_f32 v[16:17], v[16:17], v[24:25]
    v_pk_add_f32 v[18:19], v[18:19], v[26:27]
    v_rcp_f32 v20, v20
    v_rcp_f32 v21, v21
    v_rcp_f32 v22, v22
    v_rcp_f32 v23, v23
    v_pk_fma_f32 v[16:17], v[16:17], v[20:21], v[112:113]
    v_pk_fma_f32 v[18:19], v[18:19], v[22:23], v[114:115]
    v_cvt_pk_bf16_f32 v16, v16, v17
    v_cvt_pk_bf16_f32 v17, v18, v19
    v_pk_max_f16 v16, v16, v126
    v_pk_max_f16 v17, v17, v127
    s_nop 0
    buffer_store_dwordx2 v[16:17], v133, s[52:55], s94 offen sc1 nt
    s_add_u32 s94, s94, 4096
    v_permlane32_swap_b32 v32, v40
    v_permlane32_swap_b32 v36, v44
    v_permlane32_swap_b32 v33, v41
    v_permlane32_swap_b32 v37, v45
    v_permlane32_swap_b32 v34, v42
    v_permlane32_swap_b32 v38, v46
    v_permlane32_swap_b32 v35, v43
    v_permlane32_swap_b32 v39, v47
    v_pk_add_f32 v[36:37], v[36:37], v[44:45]
    v_pk_add_f32 v[38:39], v[38:39], v[46:47]
    v_pk_add_f32 v[32:33], v[32:33], v[40:41]
    v_pk_add_f32 v[34:35], v[34:35], v[42:43]
    v_rcp_f32 v36, v36
    v_rcp_f32 v37, v37
    v_rcp_f32 v38, v38
    v_rcp_f32 v39, v39
    v_pk_fma_f32 v[32:33], v[32:33], v[36:37], v[116:117]
    v_pk_fma_f32 v[34:35], v[34:35], v[38:39], v[118:119]
    v_cvt_pk_bf16_f32 v32, v32, v33
    v_cvt_pk_bf16_f32 v33, v34, v35
    v_pk_max_f16 v32, v32, v128
    v_pk_max_f16 v33, v33, v129
    s_nop 0
    buffer_store_dwordx2 v[32:33], v133, s[52:55], s94 offen sc1 nt
    s_add_u32 s94, s94, 4096
    s_add_u32 s3, s56, 48
    s_cmp_ge_u32 s3, s0
    s_cbranch_scc1 Lk2_done
    v_permlane32_swap_b32 v48, v56
    v_permlane32_swap_b32 v52, v60
    v_permlane32_swap_b32 v49, v57
    v_permlane32_swap_b32 v53, v61
    v_permlane32_swap_b32 v50, v58
    v_permlane32_swap_b32 v54, v62
    v_permlane32_swap_b32 v51, v59
    v_permlane32_swap_b32 v55, v63
    v_pk_add_f32 v[52:53], v[52:53], v[60:61]
    v_pk_add_f32 v[54:55], v[54:55], v[62:63]
    v_pk_add_f32 v[48:49], v[48:49], v[56:57]
    v_pk_add_f32 v[50:51], v[50:51], v[58:59]
    v_rcp_f32 v52, v52
    v_rcp_f32 v53, v53
    v_rcp_f32 v54, v54
    v_rcp_f32 v55, v55
    v_pk_fma_f32 v[48:49], v[48:49], v[52:53], v[120:121]
    v_pk_fma_f32 v[50:51], v[50:51], v[54:55], v[122:123]
    v_cvt_pk_bf16_f32 v48, v48, v49
    v_cvt_pk_bf16_f32 v49, v50, v51
    v_pk_max_f16 v48, v48, v130
    v_pk_max_f16 v49, v49, v131
    s_mov_b32 exec_hi, 0
    buffer_store_dwordx2 v[48:49], v133, s[52:55], s94 offen sc1 nt
    s_add_u32 s94, s94, 4096
    s_branch Lk2_done
.section .rodata,"a"
.p2align 6
.amdhsa_kernel gather_scatter__edge_featured_mpnn_gatedgcn__graph_kernel
  .amdhsa_next_free_vgpr 256
  .amdhsa_next_free_sgpr 102
  .amdhsa_accum_offset 256
  .amdhsa_group_segment_fixed_size 0
  .amdhsa_kernarg_size 96
  .amdhsa_user_sgpr_count 2
  .amdhsa_user_sgpr_kernarg_segment_ptr 1
  .amdhsa_system_sgpr_workgroup_id_x 1
  .amdhsa_fp16_overflow 1
.end_amdhsa_kernel
```
